```python
import torch

def _softmax(x, axis=-1):
    return torch.softmax(x, dim=axis)
def _gelu(x):
    return torch.nn.functional.gelu(x, approximate="tanh")
def _silu(x):
    return torch.nn.functional.silu(x)
def _sigmoid(x):
    return torch.sigmoid(x)
def _layernorm(x, axis=-1, eps=1e-5):
    m = x.mean(dim=axis, keepdim=True)
    v = x.var(dim=axis, keepdim=True, unbiased=False)
    return (x - m) / torch.sqrt(v + eps)
def _scatter_add(tgt, idx, src, axis=0):
    return tgt.clone().index_add_(axis, idx, src)
def _segment_sum(src, seg, n):
    out = torch.zeros((n,) + src.shape[1:], dtype=src.dtype)
    return out.index_add_(0, seg, src)
def _pad(x, pw):
    flat = tuple(v for pair in reversed(pw) for v in pair)
    return torch.nn.functional.pad(x, flat)

kernel_name = 'standalone__weight_only_int_squeezellm__prompt'

def setup_inputs():

    _w = (lambda a: (lambda t: t.to(torch.bfloat16) if t.is_floating_point() else t)(torch.as_tensor(a)))
    B, S, D, F = 1, 2048, 576, 4608
    bits = 3 if (2 <= 3 <= 4) else 4
    L = 2 ** bits
    qw = torch.randint(0, L, (D, F)).to(torch.int64)
    lut = (lambda *s: torch.randn(*s, dtype=torch.bfloat16) * 0.05)(L, F)
    return {
        "x": _w((lambda *s: torch.randn(*s, dtype=torch.bfloat16) * 0.05)(B, S, D)),
        "qw": _w(qw),
        "lut": _w(lut),
    }

def reference(x, qw, lut):
    w = (lambda x, i, axis: torch.take_along_dim(x, i, dim=axis))(lut, qw, axis=0)
    w = (lambda x, dt: x.to(dt))(w, x.dtype)
    return torch.einsum('bsd,df->bsf', x, w)
```

```asm
; @launch grid=(256,1,1) block=(256,1,1) lds=162816
.amdgcn_target "amdgcn-amd-amdhsa--gfx950"
.text
.globl standalone__weight_only_int_squeezellm__prompt_kernel
.p2align 12
.fill 320, 4, 0xbf800000
.p2align 8
.type standalone__weight_only_int_squeezellm__prompt_kernel,@function
standalone__weight_only_int_squeezellm__prompt_kernel:
  s_load_dwordx2 s[8:9], s[0:1], 8
  s_load_dwordx2 s[12:13], s[0:1], 16
  s_load_dwordx2 s[4:5], s[0:1], 0
  s_load_dwordx2 s[16:17], s[0:1], 24
  s_lshr_b32 s26, s2, 3
  s_and_b32 s27, s2, 1
  s_lshl_b32 s27, s27, 5
  s_add_u32 s26, s26, s27
  s_cmpk_ge_u32 s2, 0x100
  s_cselect_b32 s26, 63, s26
  s_cmp_ge_u32 s26, 63
  s_cbranch_scc1 Lend
  v_lshrrev_b32 v251, 6, v0
  v_and_b32 v252, 63, v0
  s_mul_i32 s21, s26, 37
  v_readfirstlane_b32 s20, v251
  v_and_b32 v253, 7, v0
  v_lshrrev_b32 v254, 3, v252
  v_mul_u32_u24 v232, 73728, v254
  v_lshl_add_u32 v232, v253, 4, v232
  s_lshr_b32 s21, s21, 8
  s_mul_i32 s28, s21, 7
  s_sub_u32 s22, s26, s28
  s_and_b32 s26, s2, 6
  s_mulk_i32 s26, 18
  s_lshl2_add_u32 s26, s21, s26
  s_add_u32 s26, s26, s20
  s_lshl_b32 s26, s26, 7
  s_add_u32 s29, s22, s21
  s_and_b32 s29, s29, 1
  s_and_b32 s31, s22, 2
  s_mul_i32 s59, s31, 294912
  s_mul_i32 s32, s29, 1179648
  s_add_u32 s32, s32, s59
  s_mov_b32 s10, 10616832
  s_mov_b32 s11, 0x74fac
  v_add_u32 v232, s26, v232
  v_add_u32 v233, 18432, v232
  v_add_u32 v234, 36864, v232
  v_add_u32 v235, 55296, v232
  s_getpc_b64 s[24:25]
Lpc:
  s_lshl_b32 s30, s2, 8
  s_and_b32 s30, s30, 0x7800
  v_lshrrev_b32 v140, 4, v0
  v_lshl_add_u32 v140, v140, 7, s30
  v_min_u32 v140, Lend-Lpc, v140
  v_mov_b32 v141, s25
  v_add_co_u32 v140, vcc, s24, v140
  v_lshrrev_b32 v137, 2, v252
  v_and_b32 v138, 3, v0
  v_addc_co_u32 v141, vcc, 0, v141, vcc
  global_load_dword v142, v[140:141], off
  s_mov_b32 s14, 73728
  s_mov_b32 s15, 0x20000
  s_lshr_b32 s24, s26, 1
  s_lshl_b32 s25, s20, 10
  s_add_u32 m0, s25, 98304
  v_mul_u32_u24 v137, 9216, v137
  v_lshl_add_u32 v137, v138, 4, v137
  s_waitcnt lgkmcnt(0)
  buffer_load_format_d16_xyzw v[144:145], v232, s[8:11], s32 offen
  buffer_load_format_d16_xyzw v[146:147], v233, s[8:11], s32 offen
  buffer_load_format_d16_xyzw v[148:149], v234, s[8:11], s32 offen
  buffer_load_format_d16_xyzw v[150:151], v235, s[8:11], s32 offen
  buffer_load_dwordx4 v137, s[12:15], s24 offen lds
  s_min_u32 s28, s22, 2
  s_mul_i32 s23, s22, 18
  s_add_u32 s23, s23, s28
  s_lshl_b32 s23, s23, 4
  s_lshl3_add_u32 s27, s20, s23
  s_mulk_i32 s27, 1152
  s_addk_i32 s27, 3072
  s_and_b32 s69, s21, 2
  s_mul_i32 s69, s69, 55296
  s_and_b32 s28, s20, 1
  s_lshl_b32 s28, s28, 2
  v_lshrrev_b32 v249, 4, v252
  v_xor_b32 v250, s28, v249
  v_xor_b32 v250, v250, v253
  v_mul_u32_u24 v247, 1152, v254
  v_lshl_add_u32 v247, v250, 4, v247
  v_add_u32 v247, s27, v247
  v_add_u32 v236, s69, v247
  v_subrev_u32 v250, s69, v247
  v_add_u32 v237, 35840, v236
  v_add_u32 v238, 71680, v236
  v_add_u32 v239, 107520, v250
  v_add_u32 v240, 147456, v250
  v_add_u32 v241, 183296, v250
  s_mov_b32 s6, 2362368
  s_mov_b32 s7, 0x20000
  s_lshl_b32 s50, s29, 7
  s_mul_i32 s70, s20, 6144
  s_sub_u32 s4, s4, 3072
  s_subb_u32 s5, s5, 0
  s_add_u32 m0, s70, 73728
  s_nop 0
  buffer_load_dwordx4 v236, s[4:7], s50 offen offset:0  lds
  buffer_load_dwordx4 v237, s[4:7], s50 offen offset:1024  lds
  buffer_load_dwordx4 v238, s[4:7], s50 offen offset:2048  lds
  buffer_load_dwordx4 v239, s[4:7], s50 offen offset:3072  lds
  s_add_u32 m0, s70, 77824
  s_nop 0
  buffer_load_dwordx4 v240, s[4:7], s50 offen offset:0  lds
  buffer_load_dwordx4 v241, s[4:7], s50 offen offset:1024  lds
  s_lshr_b32 s31, s31, 1
  v_bfe_u32 v248, v252, 3, 1
  v_lshlrev_b32 v143, 3, v253
  v_lshl_add_u32 v143, v248, 2, v143
  v_add_u32 v143, s25, v143
  v_add_u32 v143, 98304, v143
  s_mul_i32 s94, s31, 1179648
  s_sub_u32 s94, 589824, s94
  s_add_u32 s33, s32, s94
  s_xor_b32 s29, s29, 1
  s_mul_i32 s34, s29, 1179648
  s_add_u32 s34, s34, s59
  s_add_u32 s35, s34, s94
  s_lshl_b32 s51, s29, 7
  s_mov_b32 s18, 18874368
  s_mov_b32 s19, 0x20000
  v_and_b32 v251, 15, v252
  s_xor_b32 s29, s29, 1
  s_add_u32 s29, s29, 2
  s_and_b32 s29, s29, 7
  s_mul_i32 s36, s29, 1179648
  s_add_u32 s36, s36, s59
  s_add_u32 s37, s36, s94
  s_lshl_b32 s52, s29, 7
  s_xor_b32 s29, s29, 1
  s_mul_i32 s38, s29, 1179648
  s_add_u32 s38, s38, s59
  s_add_u32 s39, s38, s94
  s_lshl_b32 s53, s29, 7
  s_mov_b32 s72, 0x05010400
  s_mov_b32 s73, 0x07030602
  s_mov_b32 s74, 0x05040100
  s_mov_b32 s75, 0x07060302
  s_mov_b32 vcc_lo, 0x00ff00ff
  s_mov_b32 vcc_hi, 0x00ff00ff
  v_lshrrev_b32 v244, 1, v251
  v_xor_b32 v244, v244, v249
  v_lshlrev_b32 v244, 4, v244
  v_lshl_add_u32 v244, v253, 7, v244
  v_mul_u32_u24 v243, 6144, v248
  v_mul_u32_u24 v245, 9216, v248
  v_add_u32 v243, v243, v244
  v_add_u32 v245, v245, v244
  s_lshl_b32 s28, s31, 6
  v_xor_b32 v243, s28, v243
  v_xor_b32 v245, s28, v245
  v_xor_b32 v244, 64, v243
  v_xor_b32 v246, 64, v245
  s_lshr_b32 s3, 3, s22
  s_bfe_u32 s69, s21, 0x10001
  v_add_u32 v247, 218112, v247
  s_xor_b32 s29, s29, 1
  s_add_u32 s29, s29, 2
  s_and_b32 s29, s29, 7
  s_mul_i32 s40, s29, 1179648
  s_add_u32 s40, s40, s59
  s_add_u32 s41, s40, s94
  s_lshl_b32 s54, s29, 7
  s_xor_b32 s29, s29, 1
  s_mul_i32 s42, s29, 1179648
  s_add_u32 s42, s42, s59
  s_add_u32 s43, s42, s94
  s_lshl_b32 s55, s29, 7
  s_xor_b32 s29, s29, 1
  s_add_u32 s29, s29, 2
  s_and_b32 s29, s29, 7
  s_mul_i32 s44, s29, 1179648
  s_add_u32 s44, s44, s59
  s_add_u32 s45, s44, s94
  s_lshl_b32 s56, s29, 7
  s_xor_b32 s29, s29, 1
  s_mul_i32 s46, s29, 1179648
  s_add_u32 s46, s46, s59
  s_add_u32 s47, s46, s94
  s_lshl_b32 s57, s29, 7
  s_mov_b32 s29, 8
  s_mul_i32 s48, s29, 1179648
  s_add_u32 s48, s48, s59
  s_add_u32 s49, s48, s94
  s_lshl_b32 s58, s29, 7
  s_add_u32 s60, s50, 3072
  s_add_u32 s61, s51, 2048
  s_add_u32 s62, s52, 1024
  s_add_u32 s63, s53, 0
  s_add_u32 s64, s54, 3072
  s_add_u32 s65, s55, 2048
  s_add_u32 s66, s56, 1024
  s_add_u32 s67, s57, 0
  s_add_u32 s68, s58, 3072
  s_mul_i32 s71, s20, 9216
  s_mul_i32 s76, s23, 9216
  s_add_u32 s77, s76, 147456
  s_add_u32 s78, s77, 147456
  s_add_u32 s79, s78, 147456
  s_add_u32 s80, s79, 147456
  s_add_u32 s81, s80, 147456
  s_add_u32 s82, s81, 147456
  s_add_u32 s83, s82, 147456
  s_add_u32 s84, s83, 147456
  s_add_u32 s85, s84, 147456
  s_add_u32 s86, s85, 147456
  s_add_u32 s87, s86, 147456
  s_add_u32 s88, s87, 147456
  s_add_u32 s89, s88, 147456
  s_add_u32 s90, s89, 147456
  s_add_u32 s91, s90, 147456
  s_add_u32 s92, s91, 147456
  s_add_u32 s93, s92, 147456
  s_add_u32 s94, s93, 147456
  s_mul_i32 s28, s69, 884736
  s_add_u32 s76, s76, s28
  s_add_u32 s77, s77, s28
  s_add_u32 s78, s78, s28
  s_add_u32 s79, s79, s28
  s_add_u32 s80, s80, s28
  s_add_u32 s81, s81, s28
  s_sub_u32 s82, s82, s28
  s_sub_u32 s83, s83, s28
  s_sub_u32 s84, s84, s28
  s_sub_u32 s85, s85, s28
  s_sub_u32 s86, s86, s28
  s_sub_u32 s87, s87, s28
  s_bitcmp1_b32 s3, 0
  s_cselect_b32 s95, 110592, 2.0
  s_mul_i32 s30, s20, 9216
  s_min_u32 s30, s30, 18432
  s_cmp_lt_u32 s20, 2
  s_cselect_b32 s95, s95, 2.0
  v_add_u32 v254, s95, v247
  s_mul_i32 s28, s21, 21846
  s_lshr_b32 s28, s28, 16
  s_mul_i32 s28, s28, 3
  s_sub_u32 s28, s21, s28
  s_mul_i32 s27, s28, 36864
  v_add_u32 v247, s27, v247
  s_cmp_eq_u32 s28, 2
  s_cselect_b32 s96, 4294893568, 0
  s_cselect_b32 s27, 0, 36864
  s_add_u32 s96, s96, s27
  s_cmp_eq_u32 s28, 1
  s_cselect_b32 s97, 4294893568, 0
  s_cselect_b32 s27, 0, 36864
  s_add_u32 s97, s97, s27
  s_mul_i32 s27, s28, 294912
  s_add_u32 s88, s88, s27
  s_add_u32 s89, s88, 147456
  s_add_u32 s90, s90, s27
  s_cmp_ge_u32 s28, 2
  s_cselect_b32 s25, 884736, 0
  s_sub_u32 s90, s90, s25
  s_add_u32 s91, s90, 147456
  s_add_u32 s92, s92, s27
  s_cmp_ge_u32 s28, 1
  s_cselect_b32 s25, 884736, 0
  s_sub_u32 s92, s92, s25
  s_add_u32 s93, s92, 147456
  s_lshr_b32 s26, s26, 1
  v_lshl_add_u32 v250, v249, 2, v248
  v_mul_u32_u24 v250, 9216, v250
  v_lshl_add_u32 v250, v253, 3, v250
  v_add_u32 v250, s26, v250
  v_add_u32 v248, 18432, v250
  buffer_load_format_d16_xyzw v[152:153], v232, s[8:11], s33 offen
  buffer_load_format_d16_xyzw v[154:155], v233, s[8:11], s33 offen
  buffer_load_format_d16_xyzw v[156:157], v234, s[8:11], s33 offen
  buffer_load_format_d16_xyzw v[158:159], v235, s[8:11], s33 offen
  buffer_load_format_d16_xyzw v[160:161], v232, s[8:11], s34 offen
  buffer_load_format_d16_xyzw v[162:163], v233, s[8:11], s34 offen
  buffer_load_format_d16_xyzw v[164:165], v234, s[8:11], s34 offen
  buffer_load_format_d16_xyzw v[166:167], v235, s[8:11], s34 offen
  s_waitcnt vmcnt(14)
  ds_read2_b32 v[128:129], v143 offset0:0 offset1:16
  ds_read2_b32 v[130:131], v143 offset0:32 offset1:48
  ds_read2_b32 v[132:133], v143 offset0:64 offset1:80
  ds_read2_b32 v[134:135], v143 offset0:96 offset1:112
  s_waitcnt lgkmcnt(0)
  v_perm_b32 v136, v129, v128, s72
  v_perm_b32 v137, v131, v130, s72
  v_perm_b32 v224, v137, v136, s74
  v_perm_b32 v226, v137, v136, s75
  v_perm_b32 v136, v133, v132, s72
  v_perm_b32 v137, v135, v134, s72
  v_perm_b32 v225, v137, v136, s74
  v_perm_b32 v227, v137, v136, s75
  v_perm_b32 v136, v129, v128, s73
  v_perm_b32 v137, v131, v130, s73
  v_perm_b32 v228, v137, v136, s74
  v_perm_b32 v230, v137, v136, s75
  v_perm_b32 v136, v133, v132, s73
  v_perm_b32 v137, v135, v134, s73
  v_perm_b32 v229, v137, v136, s74
  v_perm_b32 v231, v137, v136, s75
  v_lshl_or_b32 v144, v146, 8, v144
  v_lshl_or_b32 v145, v147, 8, v145
  v_lshl_or_b32 v148, v150, 8, v148
  v_lshl_or_b32 v149, v151, 8, v149
  v_cndmask_b32_dpp v146, v145, v144, vcc row_ror:8 row_mask:0xf bank_mask:0xf
  s_nop 0
  v_cndmask_b32_dpp v150, v149, v148, vcc row_ror:8 row_mask:0xf bank_mask:0xf
  s_not_b64 vcc, vcc
  v_cndmask_b32_dpp v147, v144, v145, vcc row_ror:8 row_mask:0xf bank_mask:0xf
  v_cndmask_b32_dpp v151, v148, v149, vcc row_ror:8 row_mask:0xf bank_mask:0xf
  v_perm_b32 v144, v150, v146, s74
  v_perm_b32 v148, v150, v146, s75
  v_perm_b32 v145, v151, v147, s74
  v_perm_b32 v149, v151, v147, s75
  v_perm_b32 v146, v225, v224, v144
  v_perm_b32 v150, v227, v226, v144
  v_perm_b32 v0, v150, v146, s72
  v_perm_b32 v1, v150, v146, s73
  v_perm_b32 v147, v225, v224, v145
  v_perm_b32 v151, v227, v226, v145
  v_perm_b32 v2, v151, v147, s72
  v_perm_b32 v3, v151, v147, s73
  v_perm_b32 v146, v229, v228, v148
  v_perm_b32 v150, v231, v230, v148
  v_perm_b32 v4, v150, v146, s72
  v_perm_b32 v5, v150, v146, s73
  v_perm_b32 v147, v229, v228, v149
  v_perm_b32 v151, v231, v230, v149
  v_perm_b32 v6, v151, v147, s72
  v_perm_b32 v7, v151, v147, s73
  s_waitcnt vmcnt(8)
  s_barrier
  v_add_u32 v243, 49152, v243
  ds_read_b128 a[128:131], v243 offset:24576
  ds_read_b128 a[132:135], v243 offset:36864
  ds_read_b128 a[136:139], v243 offset:25600
  ds_read_b128 a[140:143], v243 offset:37888
  ds_read_b128 a[144:147], v243 offset:26624
  ds_read_b128 a[148:151], v243 offset:38912
  ds_read_b128 a[152:155], v243 offset:27648
  ds_read_b128 a[156:159], v243 offset:39936
  s_waitcnt lgkmcnt(4)
  v_mfma_f32_16x16x32_bf16 v[184:187], a[128:131], v[0:3], 0
  ds_read_b128 a[160:163], v243 offset:28672
  s_add_u32 m0, s70, 0
  v_mfma_f32_16x16x32_bf16 v[188:191], a[128:131], v[4:7], 0
  buffer_load_dwordx4 v236, s[4:7], s51 offen offset:0  lds
  s_waitcnt vmcnt(5)
  v_mfma_f32_16x16x32_bf16 v[192:195], a[132:135], v[0:3], 0
  ds_read_b128 a[164:167], v243 offset:40960
  v_lshl_or_b32 v152, v154, 8, v152
  v_lshl_or_b32 v153, v155, 8, v153
  v_mfma_f32_16x16x32_bf16 v[196:199], a[132:135], v[4:7], 0
  buffer_load_dwordx4 v237, s[4:7], s51 offen offset:1024  lds
  v_lshl_or_b32 v156, v158, 8, v156
  v_mfma_f32_16x16x32_bf16 v[200:203], a[136:139], v[0:3], 0
  ds_read_b128 a[168:171], v243 offset:29696
  v_lshl_or_b32 v157, v159, 8, v157
  v_cndmask_b32_dpp v155, v152, v153, vcc row_ror:8 row_mask:0xf bank_mask:0xf
  v_mfma_f32_16x16x32_bf16 v[204:207], a[136:139], v[4:7], 0
  buffer_load_dwordx4 v238, s[4:7], s51 offen offset:2048  lds
  v_cndmask_b32_dpp v159, v156, v157, vcc row_ror:8 row_mask:0xf bank_mask:0xf
  v_mfma_f32_16x16x32_bf16 v[208:211], a[140:143], v[0:3], 0
  ds_read_b128 a[172:175], v243 offset:41984
  s_not_b64 vcc, vcc
  v_cndmask_b32_dpp v154, v153, v152, vcc row_ror:8 row_mask:0xf bank_mask:0xf
  v_mfma_f32_16x16x32_bf16 v[212:215], a[140:143], v[4:7], 0
  buffer_load_dwordx4 v239, s[4:7], s51 offen offset:3072  lds
  s_waitcnt lgkmcnt(4)
  v_mfma_f32_16x16x32_bf16 v[216:219], a[144:147], v[0:3], 0
  v_add_u32 v244, 49152, v244
  ds_read_b128 a[128:131], v244 offset:24576
  s_add_u32 m0, s70, 4096
  v_mfma_f32_16x16x32_bf16 v[220:223], a[144:147], v[4:7], 0
  buffer_load_dwordx4 v240, s[4:7], s51 offen offset:0  lds
  v_cndmask_b32_dpp v158, v157, v156, vcc row_ror:8 row_mask:0xf bank_mask:0xf
  v_mfma_f32_16x16x32_bf16 a[40:43], a[148:151], v[0:3], 0
  ds_read_b128 a[132:135], v244 offset:36864
  v_perm_b32 v152, v158, v154, s74
  v_perm_b32 v156, v158, v154, s75
  v_mfma_f32_16x16x32_bf16 a[44:47], a[148:151], v[4:7], 0
  buffer_load_dwordx4 v241, s[4:7], s51 offen offset:1024  lds
  v_perm_b32 v153, v159, v155, s74
  v_mfma_f32_16x16x32_bf16 a[48:51], a[152:155], v[0:3], 0
  ds_read_b128 a[136:139], v244 offset:25600
  v_perm_b32 v157, v159, v155, s75
  v_perm_b32 v154, v225, v224, v152
  v_mfma_f32_16x16x32_bf16 a[52:55], a[152:155], v[4:7], 0
  buffer_load_format_d16_xyzw v[168:169], v232, s[8:11], s35 offen
  v_perm_b32 v158, v227, v226, v152
  v_mfma_f32_16x16x32_bf16 a[56:59], a[156:159], v[0:3], 0
  ds_read_b128 a[140:143], v244 offset:37888
  v_perm_b32 v8, v158, v154, s72
  v_perm_b32 v9, v158, v154, s73
  v_mfma_f32_16x16x32_bf16 a[60:63], a[156:159], v[4:7], 0
  buffer_load_format_d16_xyzw v[170:171], v233, s[8:11], s35 offen
  s_waitcnt lgkmcnt(4)
  v_mfma_f32_16x16x32_bf16 a[64:67], a[160:163], v[0:3], 0
  ds_read_b128 a[144:147], v244 offset:26624
  v_perm_b32 v155, v225, v224, v153
  v_perm_b32 v159, v227, v226, v153
  v_mfma_f32_16x16x32_bf16 a[68:71], a[160:163], v[4:7], 0
  buffer_load_format_d16_xyzw v[172:173], v234, s[8:11], s35 offen
  v_perm_b32 v10, v159, v155, s72
  v_mfma_f32_16x16x32_bf16 a[72:75], a[164:167], v[0:3], 0
  ds_read_b128 a[148:151], v244 offset:38912
  v_perm_b32 v11, v159, v155, s73
  v_perm_b32 v154, v229, v228, v156
  v_mfma_f32_16x16x32_bf16 a[76:79], a[164:167], v[4:7], 0
  buffer_load_format_d16_xyzw v[174:175], v235, s[8:11], s35 offen
  v_perm_b32 v158, v231, v230, v156
  v_mfma_f32_16x16x32_bf16 a[80:83], a[168:171], v[0:3], 0
  ds_read_b128 a[152:155], v244 offset:27648
  v_perm_b32 v12, v158, v154, s72
  v_perm_b32 v13, v158, v154, s73
  v_mfma_f32_16x16x32_bf16 a[84:87], a[168:171], v[4:7], 0
  buffer_load_format_d16_xyzw v[176:177], v232, s[8:11], s36 offen
  v_perm_b32 v155, v229, v228, v157
  v_mfma_f32_16x16x32_bf16 a[88:91], a[172:175], v[0:3], 0
  ds_read_b128 a[156:159], v244 offset:39936
  v_perm_b32 v159, v231, v230, v157
  v_perm_b32 v14, v159, v155, s72
  v_mfma_f32_16x16x32_bf16 a[92:95], a[172:175], v[4:7], 0
  buffer_load_format_d16_xyzw v[178:179], v233, s[8:11], s36 offen
  v_perm_b32 v15, v159, v155, s73
  s_waitcnt lgkmcnt(4)
  v_mfma_f32_16x16x32_bf16 v[184:187], a[128:131], v[8:11], v[184:187]
  ds_read_b128 a[160:163], v244 offset:28672
  s_waitcnt vmcnt(12)
  v_mfma_f32_16x16x32_bf16 v[188:191], a[128:131], v[12:15], v[188:191]
  buffer_load_format_d16_xyzw v[180:181], v234, s[8:11], s36 offen
  v_lshl_or_b32 v160, v162, 8, v160
  v_mfma_f32_16x16x32_bf16 v[192:195], a[132:135], v[8:11], v[192:195]
  ds_read_b128 a[164:167], v244 offset:40960
  v_lshl_or_b32 v161, v163, 8, v161
  v_lshl_or_b32 v164, v166, 8, v164
  v_mfma_f32_16x16x32_bf16 v[196:199], a[132:135], v[12:15], v[196:199]
  buffer_load_format_d16_xyzw v[182:183], v235, s[8:11], s36 offen
  v_mfma_f32_16x16x32_bf16 v[200:203], a[136:139], v[8:11], v[200:203]
  ds_read_b128 a[168:171], v244 offset:29696
  s_add_u32 m0, s70, 24576
  v_lshl_or_b32 v165, v167, 8, v165
  v_mfma_f32_16x16x32_bf16 v[204:207], a[136:139], v[12:15], v[204:207]
  buffer_load_dwordx4 v236, s[4:7], s52 offen offset:0  lds
  v_cndmask_b32_dpp v162, v161, v160, vcc row_ror:8 row_mask:0xf bank_mask:0xf
  v_mfma_f32_16x16x32_bf16 v[208:211], a[140:143], v[8:11], v[208:211]
  ds_read_b128 a[172:175], v244 offset:41984
  v_cndmask_b32_dpp v166, v165, v164, vcc row_ror:8 row_mask:0xf bank_mask:0xf
  s_not_b64 vcc, vcc
  v_mfma_f32_16x16x32_bf16 v[212:215], a[140:143], v[12:15], v[212:215]
  buffer_load_dwordx4 v237, s[4:7], s52 offen offset:1024  lds
  s_waitcnt lgkmcnt(4)
  v_mfma_f32_16x16x32_bf16 v[216:219], a[144:147], v[8:11], v[216:219]
  s_waitcnt vmcnt(10)
  s_barrier
  v_add_u32 v243, 4294918144, v243
  ds_read_b128 a[128:131], v243 offset:0
  v_mfma_f32_16x16x32_bf16 v[220:223], a[144:147], v[12:15], v[220:223]
  v_cndmask_b32_dpp v163, v160, v161, vcc row_ror:8 row_mask:0xf bank_mask:0xf
  v_cndmask_b32_dpp v167, v164, v165, vcc row_ror:8 row_mask:0xf bank_mask:0xf
  v_mfma_f32_16x16x32_bf16 a[40:43], a[148:151], v[8:11], a[40:43]
  ds_read_b128 a[132:135], v243 offset:12288
  v_perm_b32 v160, v166, v162, s74
  v_mfma_f32_16x16x32_bf16 a[44:47], a[148:151], v[12:15], a[44:47]
  buffer_load_dwordx4 v238, s[4:7], s52 offen offset:2048  lds
  v_mfma_f32_16x16x32_bf16 a[48:51], a[152:155], v[8:11], a[48:51]
  ds_read_b128 a[136:139], v243 offset:1024
  v_perm_b32 v164, v166, v162, s75
  v_perm_b32 v161, v167, v163, s74
  v_mfma_f32_16x16x32_bf16 a[52:55], a[152:155], v[12:15], a[52:55]
  v_perm_b32 v165, v167, v163, s75
  v_perm_b32 v162, v225, v224, v160
  v_perm_b32 v166, v227, v226, v160
  v_mfma_f32_16x16x32_bf16 a[56:59], a[156:159], v[8:11], a[56:59]
  ds_read_b128 a[140:143], v243 offset:13312
  buffer_load_dwordx4 v239, s[4:7], s52 offen offset:3072  lds
  v_mfma_f32_16x16x32_bf16 a[60:63], a[156:159], v[12:15], a[60:63]
  v_perm_b32 v16, v166, v162, s72
  s_waitcnt lgkmcnt(4)
  v_mfma_f32_16x16x32_bf16 a[64:67], a[160:163], v[8:11], a[64:67]
  ds_read_b128 a[144:147], v243 offset:2048
  v_perm_b32 v17, v166, v162, s73
  v_perm_b32 v163, v225, v224, v161
  v_mfma_f32_16x16x32_bf16 a[68:71], a[160:163], v[12:15], a[68:71]
  s_add_u32 m0, s70, 28672
  v_perm_b32 v167, v227, v226, v161
  v_perm_b32 v18, v167, v163, s72
  v_mfma_f32_16x16x32_bf16 a[72:75], a[164:167], v[8:11], a[72:75]
  ds_read_b128 a[148:151], v243 offset:14336
  buffer_load_dwordx4 v240, s[4:7], s52 offen offset:0  lds
  v_mfma_f32_16x16x32_bf16 a[76:79], a[164:167], v[12:15], a[76:79]
  v_perm_b32 v19, v167, v163, s73
  v_perm_b32 v162, v229, v228, v164
  v_mfma_f32_16x16x32_bf16 a[80:83], a[168:171], v[8:11], a[80:83]
  ds_read_b128 a[152:155], v243 offset:3072
  v_perm_b32 v166, v231, v230, v164
  v_perm_b32 v20, v166, v162, s72
  v_mfma_f32_16x16x32_bf16 a[84:87], a[168:171], v[12:15], a[84:87]
  buffer_load_dwordx4 v241, s[4:7], s52 offen offset:1024  lds
  v_perm_b32 v21, v166, v162, s73
  v_mfma_f32_16x16x32_bf16 a[88:91], a[172:175], v[8:11], a[88:91]
  ds_read_b128 a[156:159], v243 offset:15360
  v_perm_b32 v163, v229, v228, v165
  v_perm_b32 v167, v231, v230, v165
  v_mfma_f32_16x16x32_bf16 a[92:95], a[172:175], v[12:15], a[92:95]
  v_perm_b32 v22, v167, v163, s72
  v_perm_b32 v23, v167, v163, s73
  s_waitcnt lgkmcnt(4)
  v_mfma_f32_16x16x32_bf16 v[184:187], a[128:131], v[16:19], v[184:187]
  ds_read_b128 a[160:163], v243 offset:4096
  buffer_load_format_d16_xyzw v[144:145], v232, s[8:11], s37 offen
  v_mfma_f32_16x16x32_bf16 v[188:191], a[128:131], v[20:23], v[188:191]
  s_waitcnt vmcnt(11)
  v_lshl_or_b32 v168, v170, 8, v168
  v_mfma_f32_16x16x32_bf16 v[192:195], a[132:135], v[16:19], v[192:195]
  ds_read_b128 a[164:167], v243 offset:16384
  v_lshl_or_b32 v169, v171, 8, v169
  v_mfma_f32_16x16x32_bf16 v[196:199], a[132:135], v[20:23], v[196:199]
  v_lshl_or_b32 v172, v174, 8, v172
  v_lshl_or_b32 v173, v175, 8, v173
  v_mfma_f32_16x16x32_bf16 v[200:203], a[136:139], v[16:19], v[200:203]
  ds_read_b128 a[168:171], v243 offset:5120
  buffer_load_format_d16_xyzw v[146:147], v233, s[8:11], s37 offen
  v_mfma_f32_16x16x32_bf16 v[204:207], a[136:139], v[20:23], v[204:207]
  v_cndmask_b32_dpp v171, v168, v169, vcc row_ror:8 row_mask:0xf bank_mask:0xf
  v_cndmask_b32_dpp v175, v172, v173, vcc row_ror:8 row_mask:0xf bank_mask:0xf
  v_mfma_f32_16x16x32_bf16 v[208:211], a[140:143], v[16:19], v[208:211]
  ds_read_b128 a[172:175], v243 offset:17408
  s_not_b64 vcc, vcc
  v_cndmask_b32_dpp v170, v169, v168, vcc row_ror:8 row_mask:0xf bank_mask:0xf
  v_mfma_f32_16x16x32_bf16 v[212:215], a[140:143], v[20:23], v[212:215]
  buffer_load_format_d16_xyzw v[148:149], v234, s[8:11], s37 offen
  s_waitcnt lgkmcnt(4)
  v_mfma_f32_16x16x32_bf16 v[216:219], a[144:147], v[16:19], v[216:219]
  v_add_u32 v244, 4294918144, v244
  ds_read_b128 a[128:131], v244 offset:0
  v_mfma_f32_16x16x32_bf16 v[220:223], a[144:147], v[20:23], v[220:223]
  v_cndmask_b32_dpp v174, v173, v172, vcc row_ror:8 row_mask:0xf bank_mask:0xf
  v_perm_b32 v168, v174, v170, s74
  v_mfma_f32_16x16x32_bf16 a[40:43], a[148:151], v[16:19], a[40:43]
  ds_read_b128 a[132:135], v244 offset:12288
  v_perm_b32 v172, v174, v170, s75
  v_perm_b32 v169, v175, v171, s74
  v_mfma_f32_16x16x32_bf16 a[44:47], a[148:151], v[20:23], a[44:47]
  buffer_load_format_d16_xyzw v[150:151], v235, s[8:11], s37 offen
  v_mfma_f32_16x16x32_bf16 a[48:51], a[152:155], v[16:19], a[48:51]
  ds_read_b128 a[136:139], v244 offset:1024
  v_perm_b32 v173, v175, v171, s75
  v_perm_b32 v170, v225, v224, v168
  v_mfma_f32_16x16x32_bf16 a[52:55], a[152:155], v[20:23], a[52:55]
  v_perm_b32 v174, v227, v226, v168
  v_perm_b32 v24, v174, v170, s72
  v_mfma_f32_16x16x32_bf16 a[56:59], a[156:159], v[16:19], a[56:59]
  ds_read_b128 a[140:143], v244 offset:13312
  buffer_load_format_d16_xyzw v[152:153], v232, s[8:11], s38 offen
  v_mfma_f32_16x16x32_bf16 a[60:63], a[156:159], v[20:23], a[60:63]
  v_perm_b32 v25, v174, v170, s73
  s_waitcnt lgkmcnt(4)
  v_mfma_f32_16x16x32_bf16 a[64:67], a[160:163], v[16:19], a[64:67]
  ds_read_b128 a[144:147], v244 offset:2048
  v_perm_b32 v171, v225, v224, v169
  v_perm_b32 v175, v227, v226, v169
  v_mfma_f32_16x16x32_bf16 a[68:71], a[160:163], v[20:23], a[68:71]
  v_perm_b32 v26, v175, v171, s72
  v_perm_b32 v27, v175, v171, s73
  v_mfma_f32_16x16x32_bf16 a[72:75], a[164:167], v[16:19], a[72:75]
  ds_read_b128 a[148:151], v244 offset:14336
  buffer_load_format_d16_xyzw v[154:155], v233, s[8:11], s38 offen
  v_mfma_f32_16x16x32_bf16 a[76:79], a[164:167], v[20:23], a[76:79]
  v_perm_b32 v170, v229, v228, v172
  v_perm_b32 v174, v231, v230, v172
  v_mfma_f32_16x16x32_bf16 a[80:83], a[168:171], v[16:19], a[80:83]
  ds_read_b128 a[152:155], v244 offset:3072
  v_perm_b32 v28, v174, v170, s72
  v_perm_b32 v29, v174, v170, s73
  v_mfma_f32_16x16x32_bf16 a[84:87], a[168:171], v[20:23], a[84:87]
  buffer_load_format_d16_xyzw v[156:157], v234, s[8:11], s38 offen
  v_mfma_f32_16x16x32_bf16 a[88:91], a[172:175], v[16:19], a[88:91]
  ds_read_b128 a[156:159], v244 offset:15360
  v_perm_b32 v171, v229, v228, v173
  v_perm_b32 v175, v231, v230, v173
  v_mfma_f32_16x16x32_bf16 a[92:95], a[172:175], v[20:23], a[92:95]
  v_perm_b32 v30, v175, v171, s72
  v_perm_b32 v31, v175, v171, s73
  s_waitcnt lgkmcnt(4)
  v_mfma_f32_16x16x32_bf16 v[184:187], a[128:131], v[24:27], v[184:187]
  ds_read_b128 a[160:163], v244 offset:4096
  buffer_load_format_d16_xyzw v[158:159], v235, s[8:11], s38 offen
  v_mfma_f32_16x16x32_bf16 v[188:191], a[128:131], v[28:31], v[188:191]
  s_waitcnt vmcnt(14)
  v_lshl_or_b32 v176, v178, 8, v176
  v_mfma_f32_16x16x32_bf16 v[192:195], a[132:135], v[24:27], v[192:195]
  ds_read_b128 a[164:167], v244 offset:16384
  v_lshl_or_b32 v177, v179, 8, v177
  v_mfma_f32_16x16x32_bf16 v[196:199], a[132:135], v[28:31], v[196:199]
  s_add_u32 m0, s70, 49152
  v_lshl_or_b32 v180, v182, 8, v180
  v_lshl_or_b32 v181, v183, 8, v181
  v_mfma_f32_16x16x32_bf16 v[200:203], a[136:139], v[24:27], v[200:203]
  ds_read_b128 a[168:171], v244 offset:5120
  buffer_load_dwordx4 v236, s[4:7], s53 offen offset:0  lds
  v_mfma_f32_16x16x32_bf16 v[204:207], a[136:139], v[28:31], v[204:207]
  v_cndmask_b32_dpp v178, v177, v176, vcc row_ror:8 row_mask:0xf bank_mask:0xf
  v_cndmask_b32_dpp v182, v181, v180, vcc row_ror:8 row_mask:0xf bank_mask:0xf
  v_mfma_f32_16x16x32_bf16 v[208:211], a[140:143], v[24:27], v[208:211]
  ds_read_b128 a[172:175], v244 offset:17408
  s_not_b64 vcc, vcc
  v_cndmask_b32_dpp v179, v176, v177, vcc row_ror:8 row_mask:0xf bank_mask:0xf
  v_mfma_f32_16x16x32_bf16 v[212:215], a[140:143], v[28:31], v[212:215]
  buffer_load_dwordx4 v237, s[4:7], s53 offen offset:1024  lds
  s_waitcnt lgkmcnt(4)
  v_mfma_f32_16x16x32_bf16 v[216:219], a[144:147], v[24:27], v[216:219]
  s_waitcnt vmcnt(10)
  s_barrier
  ds_read_b128 a[128:131], v243 offset:24576
  v_mfma_f32_16x16x32_bf16 v[220:223], a[144:147], v[28:31], v[220:223]
  v_cndmask_b32_dpp v183, v180, v181, vcc row_ror:8 row_mask:0xf bank_mask:0xf
  v_perm_b32 v176, v182, v178, s74
  v_mfma_f32_16x16x32_bf16 a[40:43], a[148:151], v[24:27], a[40:43]
  ds_read_b128 a[132:135], v243 offset:36864
  v_perm_b32 v180, v182, v178, s75
  v_mfma_f32_16x16x32_bf16 a[44:47], a[148:151], v[28:31], a[44:47]
  buffer_load_dwordx4 v238, s[4:7], s53 offen offset:2048  lds
  v_perm_b32 v177, v183, v179, s74
  v_mfma_f32_16x16x32_bf16 a[48:51], a[152:155], v[24:27], a[48:51]
  ds_read_b128 a[136:139], v243 offset:25600
  v_perm_b32 v181, v183, v179, s75
  v_perm_b32 v178, v225, v224, v176
  v_mfma_f32_16x16x32_bf16 a[52:55], a[152:155], v[28:31], a[52:55]
  v_perm_b32 v182, v227, v226, v176
  v_perm_b32 v32, v182, v178, s72
  v_mfma_f32_16x16x32_bf16 a[56:59], a[156:159], v[24:27], a[56:59]
  ds_read_b128 a[140:143], v243 offset:37888
  buffer_load_dwordx4 v239, s[4:7], s53 offen offset:3072  lds
  v_mfma_f32_16x16x32_bf16 a[60:63], a[156:159], v[28:31], a[60:63]
  v_perm_b32 v33, v182, v178, s73
  s_waitcnt lgkmcnt(4)
  v_mfma_f32_16x16x32_bf16 a[64:67], a[160:163], v[24:27], a[64:67]
  ds_read_b128 a[144:147], v243 offset:26624
  v_perm_b32 v179, v225, v224, v177
  v_perm_b32 v183, v227, v226, v177
  v_mfma_f32_16x16x32_bf16 a[68:71], a[160:163], v[28:31], a[68:71]
  s_add_u32 m0, s70, 53248
  v_perm_b32 v34, v183, v179, s72
  v_perm_b32 v35, v183, v179, s73
  v_mfma_f32_16x16x32_bf16 a[72:75], a[164:167], v[24:27], a[72:75]
  ds_read_b128 a[148:151], v243 offset:38912
  buffer_load_dwordx4 v240, s[4:7], s53 offen offset:0  lds
  v_mfma_f32_16x16x32_bf16 a[76:79], a[164:167], v[28:31], a[76:79]
  v_perm_b32 v178, v229, v228, v180
  v_perm_b32 v182, v231, v230, v180
  v_mfma_f32_16x16x32_bf16 a[80:83], a[168:171], v[24:27], a[80:83]
  ds_read_b128 a[152:155], v243 offset:27648
  v_perm_b32 v36, v182, v178, s72
  v_perm_b32 v37, v182, v178, s73
  v_mfma_f32_16x16x32_bf16 a[84:87], a[168:171], v[28:31], a[84:87]
  buffer_load_dwordx4 v241, s[4:7], s53 offen offset:1024  lds
  v_mfma_f32_16x16x32_bf16 a[88:91], a[172:175], v[24:27], a[88:91]
  ds_read_b128 a[156:159], v243 offset:39936
  v_perm_b32 v179, v229, v228, v181
  v_perm_b32 v183, v231, v230, v181
  v_mfma_f32_16x16x32_bf16 a[92:95], a[172:175], v[28:31], a[92:95]
  v_perm_b32 v38, v183, v179, s72
  v_perm_b32 v39, v183, v179, s73
  s_waitcnt lgkmcnt(4)
  v_mfma_f32_16x16x32_bf16 v[184:187], a[128:131], v[32:35], v[184:187]
  ds_read_b128 a[160:163], v243 offset:28672
  buffer_load_format_d16_xyzw v[160:161], v232, s[8:11], s39 offen
  v_mfma_f32_16x16x32_bf16 v[188:191], a[128:131], v[36:39], v[188:191]
  s_waitcnt vmcnt(11)
  v_lshl_or_b32 v144, v146, 8, v144
  v_mfma_f32_16x16x32_bf16 v[192:195], a[132:135], v[32:35], v[192:195]
  ds_read_b128 a[164:167], v243 offset:40960
  v_lshl_or_b32 v145, v147, 8, v145
  v_mfma_f32_16x16x32_bf16 v[196:199], a[132:135], v[36:39], v[196:199]
  v_lshl_or_b32 v148, v150, 8, v148
  v_lshl_or_b32 v149, v151, 8, v149
  v_mfma_f32_16x16x32_bf16 v[200:203], a[136:139], v[32:35], v[200:203]
  ds_read_b128 a[168:171], v243 offset:29696
  buffer_load_format_d16_xyzw v[162:163], v233, s[8:11], s39 offen
  v_mfma_f32_16x16x32_bf16 v[204:207], a[136:139], v[36:39], v[204:207]
  v_cndmask_b32_dpp v147, v144, v145, vcc row_ror:8 row_mask:0xf bank_mask:0xf
  v_cndmask_b32_dpp v151, v148, v149, vcc row_ror:8 row_mask:0xf bank_mask:0xf
  v_mfma_f32_16x16x32_bf16 v[208:211], a[140:143], v[32:35], v[208:211]
  ds_read_b128 a[172:175], v243 offset:41984
  s_not_b64 vcc, vcc
  v_cndmask_b32_dpp v146, v145, v144, vcc row_ror:8 row_mask:0xf bank_mask:0xf
  v_mfma_f32_16x16x32_bf16 v[212:215], a[140:143], v[36:39], v[212:215]
  buffer_load_format_d16_xyzw v[164:165], v234, s[8:11], s39 offen
  s_waitcnt lgkmcnt(4)
  v_mfma_f32_16x16x32_bf16 v[216:219], a[144:147], v[32:35], v[216:219]
  ds_read_b128 a[128:131], v244 offset:24576
  v_cndmask_b32_dpp v150, v149, v148, vcc row_ror:8 row_mask:0xf bank_mask:0xf
  v_mfma_f32_16x16x32_bf16 v[220:223], a[144:147], v[36:39], v[220:223]
  v_perm_b32 v144, v150, v146, s74
  v_perm_b32 v148, v150, v146, s75
  v_mfma_f32_16x16x32_bf16 a[40:43], a[148:151], v[32:35], a[40:43]
  ds_read_b128 a[132:135], v244 offset:36864
  v_perm_b32 v145, v151, v147, s74
  v_perm_b32 v149, v151, v147, s75
  v_mfma_f32_16x16x32_bf16 a[44:47], a[148:151], v[36:39], a[44:47]
  buffer_load_format_d16_xyzw v[166:167], v235, s[8:11], s39 offen
  v_mfma_f32_16x16x32_bf16 a[48:51], a[152:155], v[32:35], a[48:51]
  ds_read_b128 a[136:139], v244 offset:25600
  v_perm_b32 v146, v225, v224, v144
  v_mfma_f32_16x16x32_bf16 a[52:55], a[152:155], v[36:39], a[52:55]
  v_perm_b32 v150, v227, v226, v144
  v_perm_b32 v40, v150, v146, s72
  v_perm_b32 v41, v150, v146, s73
  v_mfma_f32_16x16x32_bf16 a[56:59], a[156:159], v[32:35], a[56:59]
  ds_read_b128 a[140:143], v244 offset:37888
  buffer_load_format_d16_xyzw v[168:169], v232, s[8:11], s40 offen
  v_mfma_f32_16x16x32_bf16 a[60:63], a[156:159], v[36:39], a[60:63]
  v_perm_b32 v147, v225, v224, v145
  s_waitcnt lgkmcnt(4)
  v_mfma_f32_16x16x32_bf16 a[64:67], a[160:163], v[32:35], a[64:67]
  ds_read_b128 a[144:147], v244 offset:26624
  v_perm_b32 v151, v227, v226, v145
  v_mfma_f32_16x16x32_bf16 a[68:71], a[160:163], v[36:39], a[68:71]
  v_perm_b32 v42, v151, v147, s72
  v_perm_b32 v43, v151, v147, s73
  v_perm_b32 v146, v229, v228, v148
  v_mfma_f32_16x16x32_bf16 a[72:75], a[164:167], v[32:35], a[72:75]
  ds_read_b128 a[148:151], v244 offset:38912
  buffer_load_format_d16_xyzw v[170:171], v233, s[8:11], s40 offen
  v_mfma_f32_16x16x32_bf16 a[76:79], a[164:167], v[36:39], a[76:79]
  v_perm_b32 v150, v231, v230, v148
  v_perm_b32 v44, v150, v146, s72
  v_mfma_f32_16x16x32_bf16 a[80:83], a[168:171], v[32:35], a[80:83]
  ds_read_b128 a[152:155], v244 offset:27648
  v_perm_b32 v45, v150, v146, s73
  v_mfma_f32_16x16x32_bf16 a[84:87], a[168:171], v[36:39], a[84:87]
  buffer_load_format_d16_xyzw v[172:173], v234, s[8:11], s40 offen
  v_perm_b32 v147, v229, v228, v149
  v_mfma_f32_16x16x32_bf16 a[88:91], a[172:175], v[32:35], a[88:91]
  ds_read_b128 a[156:159], v244 offset:39936
  v_perm_b32 v151, v231, v230, v149
  v_mfma_f32_16x16x32_bf16 a[92:95], a[172:175], v[36:39], a[92:95]
  v_perm_b32 v46, v151, v147, s72
  v_perm_b32 v47, v151, v147, s73
  s_waitcnt lgkmcnt(4)
  v_mfma_f32_16x16x32_bf16 v[184:187], a[128:131], v[40:43], v[184:187]
  ds_read_b128 a[160:163], v244 offset:28672
  buffer_load_format_d16_xyzw v[174:175], v235, s[8:11], s40 offen
  v_mfma_f32_16x16x32_bf16 v[188:191], a[128:131], v[44:47], v[188:191]
  s_waitcnt vmcnt(14)
  v_lshl_or_b32 v152, v154, 8, v152
  v_mfma_f32_16x16x32_bf16 v[192:195], a[132:135], v[40:43], v[192:195]
  ds_read_b128 a[164:167], v244 offset:40960
  v_lshl_or_b32 v153, v155, 8, v153
  v_mfma_f32_16x16x32_bf16 v[196:199], a[132:135], v[44:47], v[196:199]
  s_add_u32 m0, s70, 73728
  v_lshl_or_b32 v156, v158, 8, v156
  v_lshl_or_b32 v157, v159, 8, v157
  v_mfma_f32_16x16x32_bf16 v[200:203], a[136:139], v[40:43], v[200:203]
  ds_read_b128 a[168:171], v244 offset:29696
  buffer_load_dwordx4 v236, s[4:7], s54 offen offset:0  lds
  v_mfma_f32_16x16x32_bf16 v[204:207], a[136:139], v[44:47], v[204:207]
  v_cndmask_b32_dpp v154, v153, v152, vcc row_ror:8 row_mask:0xf bank_mask:0xf
  v_cndmask_b32_dpp v158, v157, v156, vcc row_ror:8 row_mask:0xf bank_mask:0xf
  v_mfma_f32_16x16x32_bf16 v[208:211], a[140:143], v[40:43], v[208:211]
  ds_read_b128 a[172:175], v244 offset:41984
  s_not_b64 vcc, vcc
  v_cndmask_b32_dpp v155, v152, v153, vcc row_ror:8 row_mask:0xf bank_mask:0xf
  v_mfma_f32_16x16x32_bf16 v[212:215], a[140:143], v[44:47], v[212:215]
  buffer_load_dwordx4 v237, s[4:7], s54 offen offset:1024  lds
  s_waitcnt lgkmcnt(4)
  v_mfma_f32_16x16x32_bf16 v[216:219], a[144:147], v[40:43], v[216:219]
  s_waitcnt vmcnt(10)
  s_barrier
  ds_read_b128 a[128:131], v243 offset:49152
  v_mfma_f32_16x16x32_bf16 v[220:223], a[144:147], v[44:47], v[220:223]
  v_cndmask_b32_dpp v159, v156, v157, vcc row_ror:8 row_mask:0xf bank_mask:0xf
  v_perm_b32 v152, v158, v154, s74
  v_mfma_f32_16x16x32_bf16 a[40:43], a[148:151], v[40:43], a[40:43]
  ds_read_b128 a[132:135], v243 offset:61440
  v_perm_b32 v156, v158, v154, s75
  v_mfma_f32_16x16x32_bf16 a[44:47], a[148:151], v[44:47], a[44:47]
  buffer_load_dwordx4 v238, s[4:7], s54 offen offset:2048  lds
  v_perm_b32 v153, v159, v155, s74
  v_mfma_f32_16x16x32_bf16 a[48:51], a[152:155], v[40:43], a[48:51]
  ds_read_b128 a[136:139], v243 offset:50176
  v_perm_b32 v157, v159, v155, s75
  v_perm_b32 v154, v225, v224, v152
  v_mfma_f32_16x16x32_bf16 a[52:55], a[152:155], v[44:47], a[52:55]
  v_perm_b32 v158, v227, v226, v152
  v_perm_b32 v48, v158, v154, s72
  v_mfma_f32_16x16x32_bf16 a[56:59], a[156:159], v[40:43], a[56:59]
  ds_read_b128 a[140:143], v243 offset:62464
  buffer_load_dwordx4 v239, s[4:7], s54 offen offset:3072  lds
  v_mfma_f32_16x16x32_bf16 a[60:63], a[156:159], v[44:47], a[60:63]
  v_perm_b32 v49, v158, v154, s73
  s_waitcnt lgkmcnt(4)
  v_mfma_f32_16x16x32_bf16 a[64:67], a[160:163], v[40:43], a[64:67]
  ds_read_b128 a[144:147], v243 offset:51200
  v_perm_b32 v155, v225, v224, v153
  v_perm_b32 v159, v227, v226, v153
  v_mfma_f32_16x16x32_bf16 a[68:71], a[160:163], v[44:47], a[68:71]
  s_add_u32 m0, s70, 77824
  v_perm_b32 v50, v159, v155, s72
  v_perm_b32 v51, v159, v155, s73
  v_mfma_f32_16x16x32_bf16 a[72:75], a[164:167], v[40:43], a[72:75]
  ds_read_b128 a[148:151], v243 offset:63488
  buffer_load_dwordx4 v240, s[4:7], s54 offen offset:0  lds
  v_mfma_f32_16x16x32_bf16 a[76:79], a[164:167], v[44:47], a[76:79]
  v_perm_b32 v154, v229, v228, v156
  v_perm_b32 v158, v231, v230, v156
  v_mfma_f32_16x16x32_bf16 a[80:83], a[168:171], v[40:43], a[80:83]
  ds_read_b128 a[152:155], v243 offset:52224
  v_perm_b32 v52, v158, v154, s72
  v_perm_b32 v53, v158, v154, s73
  v_mfma_f32_16x16x32_bf16 a[84:87], a[168:171], v[44:47], a[84:87]
  buffer_load_dwordx4 v241, s[4:7], s54 offen offset:1024  lds
  v_mfma_f32_16x16x32_bf16 a[88:91], a[172:175], v[40:43], a[88:91]
  ds_read_b128 a[156:159], v243 offset:64512
  v_perm_b32 v155, v229, v228, v157
  v_perm_b32 v159, v231, v230, v157
  v_mfma_f32_16x16x32_bf16 a[92:95], a[172:175], v[44:47], a[92:95]
  v_perm_b32 v54, v159, v155, s72
  v_perm_b32 v55, v159, v155, s73
  s_waitcnt lgkmcnt(4)
  v_mfma_f32_16x16x32_bf16 v[184:187], a[128:131], v[48:51], v[184:187]
  ds_read_b128 a[160:163], v243 offset:53248
  buffer_load_format_d16_xyzw v[176:177], v232, s[8:11], s41 offen
  v_mfma_f32_16x16x32_bf16 v[188:191], a[128:131], v[52:55], v[188:191]
  s_waitcnt vmcnt(11)
  v_lshl_or_b32 v160, v162, 8, v160
  v_mfma_f32_16x16x32_bf16 v[192:195], a[132:135], v[48:51], v[192:195]
  v_add_u32 v243, 49152, v243
  ds_read_b128 a[164:167], v243 offset:16384
  v_mfma_f32_16x16x32_bf16 v[196:199], a[132:135], v[52:55], v[196:199]
  v_lshl_or_b32 v161, v163, 8, v161
  v_lshl_or_b32 v164, v166, 8, v164
  v_mfma_f32_16x16x32_bf16 v[200:203], a[136:139], v[48:51], v[200:203]
  ds_read_b128 a[168:171], v243 offset:5120
  buffer_load_format_d16_xyzw v[178:179], v233, s[8:11], s41 offen
  v_mfma_f32_16x16x32_bf16 v[204:207], a[136:139], v[52:55], v[204:207]
  v_lshl_or_b32 v165, v167, 8, v165
  v_cndmask_b32_dpp v163, v160, v161, vcc row_ror:8 row_mask:0xf bank_mask:0xf
  v_mfma_f32_16x16x32_bf16 v[208:211], a[140:143], v[48:51], v[208:211]
  ds_read_b128 a[172:175], v243 offset:17408
  v_cndmask_b32_dpp v167, v164, v165, vcc row_ror:8 row_mask:0xf bank_mask:0xf
  s_not_b64 vcc, vcc
  v_mfma_f32_16x16x32_bf16 v[212:215], a[140:143], v[52:55], v[212:215]
  buffer_load_format_d16_xyzw v[180:181], v234, s[8:11], s41 offen
  s_waitcnt lgkmcnt(4)
  v_mfma_f32_16x16x32_bf16 v[216:219], a[144:147], v[48:51], v[216:219]
  ds_read_b128 a[128:131], v244 offset:49152
  v_cndmask_b32_dpp v162, v161, v160, vcc row_ror:8 row_mask:0xf bank_mask:0xf
  v_mfma_f32_16x16x32_bf16 v[220:223], a[144:147], v[52:55], v[220:223]
  v_cndmask_b32_dpp v166, v165, v164, vcc row_ror:8 row_mask:0xf bank_mask:0xf
  v_perm_b32 v160, v166, v162, s74
  v_mfma_f32_16x16x32_bf16 a[40:43], a[148:151], v[48:51], a[40:43]
  ds_read_b128 a[132:135], v244 offset:61440
  v_perm_b32 v164, v166, v162, s75
  v_perm_b32 v161, v167, v163, s74
  v_mfma_f32_16x16x32_bf16 a[44:47], a[148:151], v[52:55], a[44:47]
  buffer_load_format_d16_xyzw v[182:183], v235, s[8:11], s41 offen
  v_mfma_f32_16x16x32_bf16 a[48:51], a[152:155], v[48:51], a[48:51]
  ds_read_b128 a[136:139], v244 offset:50176
  v_perm_b32 v165, v167, v163, s75
  v_perm_b32 v162, v225, v224, v160
  v_mfma_f32_16x16x32_bf16 a[52:55], a[152:155], v[52:55], a[52:55]
  v_perm_b32 v166, v227, v226, v160
  v_perm_b32 v56, v166, v162, s72
  v_mfma_f32_16x16x32_bf16 a[56:59], a[156:159], v[48:51], a[56:59]
  ds_read_b128 a[140:143], v244 offset:62464
  buffer_load_format_d16_xyzw v[144:145], v232, s[8:11], s42 offen
  v_mfma_f32_16x16x32_bf16 a[60:63], a[156:159], v[52:55], a[60:63]
  v_perm_b32 v57, v166, v162, s73
  s_waitcnt lgkmcnt(4)
  v_mfma_f32_16x16x32_bf16 a[64:67], a[160:163], v[48:51], a[64:67]
  ds_read_b128 a[144:147], v244 offset:51200
  v_perm_b32 v163, v225, v224, v161
  v_perm_b32 v167, v227, v226, v161
  v_mfma_f32_16x16x32_bf16 a[68:71], a[160:163], v[52:55], a[68:71]
  v_perm_b32 v58, v167, v163, s72
  v_perm_b32 v59, v167, v163, s73
  v_mfma_f32_16x16x32_bf16 a[72:75], a[164:167], v[48:51], a[72:75]
  ds_read_b128 a[148:151], v244 offset:63488
  buffer_load_format_d16_xyzw v[146:147], v233, s[8:11], s42 offen
  v_mfma_f32_16x16x32_bf16 a[76:79], a[164:167], v[52:55], a[76:79]
  v_perm_b32 v162, v229, v228, v164
  v_perm_b32 v166, v231, v230, v164
  v_mfma_f32_16x16x32_bf16 a[80:83], a[168:171], v[48:51], a[80:83]
  ds_read_b128 a[152:155], v244 offset:52224
  v_perm_b32 v60, v166, v162, s72
  v_perm_b32 v61, v166, v162, s73
  v_mfma_f32_16x16x32_bf16 a[84:87], a[168:171], v[52:55], a[84:87]
  buffer_load_format_d16_xyzw v[148:149], v234, s[8:11], s42 offen
  v_mfma_f32_16x16x32_bf16 a[88:91], a[172:175], v[48:51], a[88:91]
  ds_read_b128 a[156:159], v244 offset:64512
  v_perm_b32 v163, v229, v228, v165
  v_perm_b32 v167, v231, v230, v165
  v_mfma_f32_16x16x32_bf16 a[92:95], a[172:175], v[52:55], a[92:95]
  v_perm_b32 v62, v167, v163, s72
  v_perm_b32 v63, v167, v163, s73
  s_waitcnt lgkmcnt(4)
  v_mfma_f32_16x16x32_bf16 v[184:187], a[128:131], v[56:59], v[184:187]
  ds_read_b128 a[160:163], v244 offset:53248
  buffer_load_format_d16_xyzw v[150:151], v235, s[8:11], s42 offen
  v_mfma_f32_16x16x32_bf16 v[188:191], a[128:131], v[60:63], v[188:191]
  s_waitcnt vmcnt(14)
  v_lshl_or_b32 v168, v170, 8, v168
  v_mfma_f32_16x16x32_bf16 v[192:195], a[132:135], v[56:59], v[192:195]
  v_add_u32 v244, 49152, v244
  ds_read_b128 a[164:167], v244 offset:16384
  v_mfma_f32_16x16x32_bf16 v[196:199], a[132:135], v[60:63], v[196:199]
  s_add_u32 m0, s70, 0
  v_lshl_or_b32 v169, v171, 8, v169
  v_lshl_or_b32 v172, v174, 8, v172
  v_mfma_f32_16x16x32_bf16 v[200:203], a[136:139], v[56:59], v[200:203]
  ds_read_b128 a[168:171], v244 offset:5120
  buffer_load_dwordx4 v236, s[4:7], s55 offen offset:0  lds
  v_mfma_f32_16x16x32_bf16 v[204:207], a[136:139], v[60:63], v[204:207]
  v_lshl_or_b32 v173, v175, 8, v173
  v_cndmask_b32_dpp v170, v169, v168, vcc row_ror:8 row_mask:0xf bank_mask:0xf
  v_mfma_f32_16x16x32_bf16 v[208:211], a[140:143], v[56:59], v[208:211]
  ds_read_b128 a[172:175], v244 offset:17408
  v_cndmask_b32_dpp v174, v173, v172, vcc row_ror:8 row_mask:0xf bank_mask:0xf
  s_not_b64 vcc, vcc
  v_mfma_f32_16x16x32_bf16 v[212:215], a[140:143], v[60:63], v[212:215]
  buffer_load_dwordx4 v237, s[4:7], s55 offen offset:1024  lds
  s_waitcnt lgkmcnt(4)
  v_mfma_f32_16x16x32_bf16 v[216:219], a[144:147], v[56:59], v[216:219]
  s_waitcnt vmcnt(10)
  s_barrier
  ds_read_b128 a[128:131], v243 offset:24576
  v_mfma_f32_16x16x32_bf16 v[220:223], a[144:147], v[60:63], v[220:223]
  v_cndmask_b32_dpp v171, v168, v169, vcc row_ror:8 row_mask:0xf bank_mask:0xf
  v_cndmask_b32_dpp v175, v172, v173, vcc row_ror:8 row_mask:0xf bank_mask:0xf
  v_mfma_f32_16x16x32_bf16 a[40:43], a[148:151], v[56:59], a[40:43]
  ds_read_b128 a[132:135], v243 offset:36864
  v_perm_b32 v168, v174, v170, s74
  v_perm_b32 v172, v174, v170, s75
  v_mfma_f32_16x16x32_bf16 a[44:47], a[148:151], v[60:63], a[44:47]
  buffer_load_dwordx4 v238, s[4:7], s55 offen offset:2048  lds
  v_mfma_f32_16x16x32_bf16 a[48:51], a[152:155], v[56:59], a[48:51]
  ds_read_b128 a[136:139], v243 offset:25600
  v_perm_b32 v169, v175, v171, s74
  v_perm_b32 v173, v175, v171, s75
  v_mfma_f32_16x16x32_bf16 a[52:55], a[152:155], v[60:63], a[52:55]
  v_perm_b32 v170, v225, v224, v168
  v_perm_b32 v174, v227, v226, v168
  v_perm_b32 v64, v174, v170, s72
  v_mfma_f32_16x16x32_bf16 a[56:59], a[156:159], v[56:59], a[56:59]
  ds_read_b128 a[140:143], v243 offset:37888
  buffer_load_dwordx4 v239, s[4:7], s55 offen offset:3072  lds
  v_mfma_f32_16x16x32_bf16 a[60:63], a[156:159], v[60:63], a[60:63]
  v_perm_b32 v65, v174, v170, s73
  s_waitcnt lgkmcnt(4)
  v_mfma_f32_16x16x32_bf16 a[64:67], a[160:163], v[56:59], a[64:67]
  ds_read_b128 a[144:147], v243 offset:26624
  v_perm_b32 v171, v225, v224, v169
  v_perm_b32 v175, v227, v226, v169
  v_mfma_f32_16x16x32_bf16 a[68:71], a[160:163], v[60:63], a[68:71]
  s_add_u32 m0, s70, 4096
  v_perm_b32 v66, v175, v171, s72
  v_mfma_f32_16x16x32_bf16 a[72:75], a[164:167], v[56:59], a[72:75]
  ds_read_b128 a[148:151], v243 offset:38912
  buffer_load_dwordx4 v240, s[4:7], s55 offen offset:0  lds
  v_mfma_f32_16x16x32_bf16 a[76:79], a[164:167], v[60:63], a[76:79]
  v_perm_b32 v67, v175, v171, s73
  v_perm_b32 v170, v229, v228, v172
  v_perm_b32 v174, v231, v230, v172
  v_mfma_f32_16x16x32_bf16 a[80:83], a[168:171], v[56:59], a[80:83]
  ds_read_b128 a[152:155], v243 offset:27648
  v_perm_b32 v68, v174, v170, s72
  v_mfma_f32_16x16x32_bf16 a[84:87], a[168:171], v[60:63], a[84:87]
  buffer_load_dwordx4 v241, s[4:7], s55 offen offset:1024  lds
  v_perm_b32 v69, v174, v170, s73
  v_mfma_f32_16x16x32_bf16 a[88:91], a[172:175], v[56:59], a[88:91]
  ds_read_b128 a[156:159], v243 offset:39936
  v_perm_b32 v171, v229, v228, v173
  v_perm_b32 v175, v231, v230, v173
  v_mfma_f32_16x16x32_bf16 a[92:95], a[172:175], v[60:63], a[92:95]
  v_perm_b32 v70, v175, v171, s72
  v_perm_b32 v71, v175, v171, s73
  s_waitcnt lgkmcnt(4)
  v_mfma_f32_16x16x32_bf16 v[184:187], a[128:131], v[64:67], v[184:187]
  ds_read_b128 a[160:163], v243 offset:28672
  buffer_load_format_d16_xyzw v[152:153], v232, s[8:11], s43 offen
  v_mfma_f32_16x16x32_bf16 v[188:191], a[128:131], v[68:71], v[188:191]
  s_waitcnt vmcnt(11)
  v_lshl_or_b32 v176, v178, 8, v176
  v_mfma_f32_16x16x32_bf16 v[192:195], a[132:135], v[64:67], v[192:195]
  ds_read_b128 a[164:167], v243 offset:40960
  v_lshl_or_b32 v177, v179, 8, v177
  v_mfma_f32_16x16x32_bf16 v[196:199], a[132:135], v[68:71], v[196:199]
  v_lshl_or_b32 v180, v182, 8, v180
  v_lshl_or_b32 v181, v183, 8, v181
  v_mfma_f32_16x16x32_bf16 v[200:203], a[136:139], v[64:67], v[200:203]
  ds_read_b128 a[168:171], v243 offset:29696
  buffer_load_format_d16_xyzw v[154:155], v233, s[8:11], s43 offen
  v_mfma_f32_16x16x32_bf16 v[204:207], a[136:139], v[68:71], v[204:207]
  v_cndmask_b32_dpp v179, v176, v177, vcc row_ror:8 row_mask:0xf bank_mask:0xf
  v_cndmask_b32_dpp v183, v180, v181, vcc row_ror:8 row_mask:0xf bank_mask:0xf
  v_mfma_f32_16x16x32_bf16 v[208:211], a[140:143], v[64:67], v[208:211]
  ds_read_b128 a[172:175], v243 offset:41984
  s_not_b64 vcc, vcc
  v_cndmask_b32_dpp v178, v177, v176, vcc row_ror:8 row_mask:0xf bank_mask:0xf
  v_mfma_f32_16x16x32_bf16 v[212:215], a[140:143], v[68:71], v[212:215]
  buffer_load_format_d16_xyzw v[156:157], v234, s[8:11], s43 offen
  s_waitcnt lgkmcnt(4)
  v_mfma_f32_16x16x32_bf16 v[216:219], a[144:147], v[64:67], v[216:219]
  ds_read_b128 a[128:131], v244 offset:24576
  v_cndmask_b32_dpp v182, v181, v180, vcc row_ror:8 row_mask:0xf bank_mask:0xf
  v_mfma_f32_16x16x32_bf16 v[220:223], a[144:147], v[68:71], v[220:223]
  v_perm_b32 v176, v182, v178, s74
  v_perm_b32 v180, v182, v178, s75
  v_mfma_f32_16x16x32_bf16 a[40:43], a[148:151], v[64:67], a[40:43]
  ds_read_b128 a[132:135], v244 offset:36864
  v_perm_b32 v177, v183, v179, s74
  v_perm_b32 v181, v183, v179, s75
  v_mfma_f32_16x16x32_bf16 a[44:47], a[148:151], v[68:71], a[44:47]
  buffer_load_format_d16_xyzw v[158:159], v235, s[8:11], s43 offen
  v_mfma_f32_16x16x32_bf16 a[48:51], a[152:155], v[64:67], a[48:51]
  ds_read_b128 a[136:139], v244 offset:25600
  v_perm_b32 v178, v225, v224, v176
  v_mfma_f32_16x16x32_bf16 a[52:55], a[152:155], v[68:71], a[52:55]
  v_perm_b32 v182, v227, v226, v176
  v_perm_b32 v72, v182, v178, s72
  v_perm_b32 v73, v182, v178, s73
  v_mfma_f32_16x16x32_bf16 a[56:59], a[156:159], v[64:67], a[56:59]
  ds_read_b128 a[140:143], v244 offset:37888
  buffer_load_format_d16_xyzw v[160:161], v232, s[8:11], s44 offen
  v_mfma_f32_16x16x32_bf16 a[60:63], a[156:159], v[68:71], a[60:63]
  v_perm_b32 v179, v225, v224, v177
  s_waitcnt lgkmcnt(4)
  v_mfma_f32_16x16x32_bf16 a[64:67], a[160:163], v[64:67], a[64:67]
  ds_read_b128 a[144:147], v244 offset:26624
  v_perm_b32 v183, v227, v226, v177
  v_mfma_f32_16x16x32_bf16 a[68:71], a[160:163], v[68:71], a[68:71]
  v_perm_b32 v74, v183, v179, s72
  v_perm_b32 v75, v183, v179, s73
  v_perm_b32 v178, v229, v228, v180
  v_mfma_f32_16x16x32_bf16 a[72:75], a[164:167], v[64:67], a[72:75]
  ds_read_b128 a[148:151], v244 offset:38912
  buffer_load_format_d16_xyzw v[162:163], v233, s[8:11], s44 offen
  v_mfma_f32_16x16x32_bf16 a[76:79], a[164:167], v[68:71], a[76:79]
  v_perm_b32 v182, v231, v230, v180
  v_perm_b32 v76, v182, v178, s72
  v_mfma_f32_16x16x32_bf16 a[80:83], a[168:171], v[64:67], a[80:83]
  ds_read_b128 a[152:155], v244 offset:27648
  v_perm_b32 v77, v182, v178, s73
  v_mfma_f32_16x16x32_bf16 a[84:87], a[168:171], v[68:71], a[84:87]
  buffer_load_format_d16_xyzw v[164:165], v234, s[8:11], s44 offen
  v_perm_b32 v179, v229, v228, v181
  v_mfma_f32_16x16x32_bf16 a[88:91], a[172:175], v[64:67], a[88:91]
  ds_read_b128 a[156:159], v244 offset:39936
  v_perm_b32 v183, v231, v230, v181
  v_mfma_f32_16x16x32_bf16 a[92:95], a[172:175], v[68:71], a[92:95]
  v_perm_b32 v78, v183, v179, s72
  v_perm_b32 v79, v183, v179, s73
  s_waitcnt lgkmcnt(4)
  v_mfma_f32_16x16x32_bf16 v[184:187], a[128:131], v[72:75], v[184:187]
  ds_read_b128 a[160:163], v244 offset:28672
  buffer_load_format_d16_xyzw v[166:167], v235, s[8:11], s44 offen
  v_mfma_f32_16x16x32_bf16 v[188:191], a[128:131], v[76:79], v[188:191]
  s_waitcnt vmcnt(14)
  v_lshl_or_b32 v144, v146, 8, v144
  v_mfma_f32_16x16x32_bf16 v[192:195], a[132:135], v[72:75], v[192:195]
  ds_read_b128 a[164:167], v244 offset:40960
  v_lshl_or_b32 v145, v147, 8, v145
  v_mfma_f32_16x16x32_bf16 v[196:199], a[132:135], v[76:79], v[196:199]
  s_add_u32 m0, s70, 24576
  v_lshl_or_b32 v148, v150, 8, v148
  v_lshl_or_b32 v149, v151, 8, v149
  v_mfma_f32_16x16x32_bf16 v[200:203], a[136:139], v[72:75], v[200:203]
  ds_read_b128 a[168:171], v244 offset:29696
  buffer_load_dwordx4 v236, s[4:7], s56 offen offset:0  lds
  v_mfma_f32_16x16x32_bf16 v[204:207], a[136:139], v[76:79], v[204:207]
  v_cndmask_b32_dpp v146, v145, v144, vcc row_ror:8 row_mask:0xf bank_mask:0xf
  v_cndmask_b32_dpp v150, v149, v148, vcc row_ror:8 row_mask:0xf bank_mask:0xf
  v_mfma_f32_16x16x32_bf16 v[208:211], a[140:143], v[72:75], v[208:211]
  ds_read_b128 a[172:175], v244 offset:41984
  s_not_b64 vcc, vcc
  v_cndmask_b32_dpp v147, v144, v145, vcc row_ror:8 row_mask:0xf bank_mask:0xf
  v_mfma_f32_16x16x32_bf16 v[212:215], a[140:143], v[76:79], v[212:215]
  buffer_load_dwordx4 v237, s[4:7], s56 offen offset:1024  lds
  s_waitcnt lgkmcnt(4)
  v_mfma_f32_16x16x32_bf16 v[216:219], a[144:147], v[72:75], v[216:219]
  s_waitcnt vmcnt(10)
  s_barrier
  v_add_u32 v243, 4294918144, v243
  ds_read_b128 a[128:131], v243 offset:0
  v_mfma_f32_16x16x32_bf16 v[220:223], a[144:147], v[76:79], v[220:223]
  v_cndmask_b32_dpp v151, v148, v149, vcc row_ror:8 row_mask:0xf bank_mask:0xf
  v_perm_b32 v144, v150, v146, s74
  v_mfma_f32_16x16x32_bf16 a[40:43], a[148:151], v[72:75], a[40:43]
  ds_read_b128 a[132:135], v243 offset:12288
  v_perm_b32 v148, v150, v146, s75
  v_mfma_f32_16x16x32_bf16 a[44:47], a[148:151], v[76:79], a[44:47]
  buffer_load_dwordx4 v238, s[4:7], s56 offen offset:2048  lds
  v_mfma_f32_16x16x32_bf16 a[48:51], a[152:155], v[72:75], a[48:51]
  ds_read_b128 a[136:139], v243 offset:1024
  v_perm_b32 v145, v151, v147, s74
  v_perm_b32 v149, v151, v147, s75
  v_mfma_f32_16x16x32_bf16 a[52:55], a[152:155], v[76:79], a[52:55]
  v_perm_b32 v146, v225, v224, v144
  v_perm_b32 v150, v227, v226, v144
  v_perm_b32 v80, v150, v146, s72
  v_mfma_f32_16x16x32_bf16 a[56:59], a[156:159], v[72:75], a[56:59]
  ds_read_b128 a[140:143], v243 offset:13312
  buffer_load_dwordx4 v239, s[4:7], s56 offen offset:3072  lds
  v_mfma_f32_16x16x32_bf16 a[60:63], a[156:159], v[76:79], a[60:63]
  v_perm_b32 v81, v150, v146, s73
  s_waitcnt lgkmcnt(4)
  v_mfma_f32_16x16x32_bf16 a[64:67], a[160:163], v[72:75], a[64:67]
  ds_read_b128 a[144:147], v243 offset:2048
  v_perm_b32 v147, v225, v224, v145
  v_perm_b32 v151, v227, v226, v145
  v_mfma_f32_16x16x32_bf16 a[68:71], a[160:163], v[76:79], a[68:71]
  s_add_u32 m0, s70, 28672
  v_perm_b32 v82, v151, v147, s72
  v_mfma_f32_16x16x32_bf16 a[72:75], a[164:167], v[72:75], a[72:75]
  ds_read_b128 a[148:151], v243 offset:14336
  buffer_load_dwordx4 v240, s[4:7], s56 offen offset:0  lds
  v_mfma_f32_16x16x32_bf16 a[76:79], a[164:167], v[76:79], a[76:79]
  v_perm_b32 v83, v151, v147, s73
  v_perm_b32 v146, v229, v228, v148
  v_perm_b32 v150, v231, v230, v148
  v_mfma_f32_16x16x32_bf16 a[80:83], a[168:171], v[72:75], a[80:83]
  ds_read_b128 a[152:155], v243 offset:3072
  v_perm_b32 v84, v150, v146, s72
  v_mfma_f32_16x16x32_bf16 a[84:87], a[168:171], v[76:79], a[84:87]
  buffer_load_dwordx4 v241, s[4:7], s56 offen offset:1024  lds
  v_perm_b32 v85, v150, v146, s73
  v_mfma_f32_16x16x32_bf16 a[88:91], a[172:175], v[72:75], a[88:91]
  ds_read_b128 a[156:159], v243 offset:15360
  v_perm_b32 v147, v229, v228, v149
  v_perm_b32 v151, v231, v230, v149
  v_mfma_f32_16x16x32_bf16 a[92:95], a[172:175], v[76:79], a[92:95]
  v_perm_b32 v86, v151, v147, s72
  v_perm_b32 v87, v151, v147, s73
  s_waitcnt lgkmcnt(4)
  v_mfma_f32_16x16x32_bf16 v[184:187], a[128:131], v[80:83], v[184:187]
  ds_read_b128 a[160:163], v243 offset:4096
  buffer_load_format_d16_xyzw v[168:169], v232, s[8:11], s45 offen
  v_mfma_f32_16x16x32_bf16 v[188:191], a[128:131], v[84:87], v[188:191]
  s_waitcnt vmcnt(11)
  v_lshl_or_b32 v152, v154, 8, v152
  v_mfma_f32_16x16x32_bf16 v[192:195], a[132:135], v[80:83], v[192:195]
  ds_read_b128 a[164:167], v243 offset:16384
  v_lshl_or_b32 v153, v155, 8, v153
  v_mfma_f32_16x16x32_bf16 v[196:199], a[132:135], v[84:87], v[196:199]
  v_lshl_or_b32 v156, v158, 8, v156
  v_lshl_or_b32 v157, v159, 8, v157
  v_mfma_f32_16x16x32_bf16 v[200:203], a[136:139], v[80:83], v[200:203]
  ds_read_b128 a[168:171], v243 offset:5120
  buffer_load_format_d16_xyzw v[170:171], v233, s[8:11], s45 offen
  v_mfma_f32_16x16x32_bf16 v[204:207], a[136:139], v[84:87], v[204:207]
  v_cndmask_b32_dpp v155, v152, v153, vcc row_ror:8 row_mask:0xf bank_mask:0xf
  v_cndmask_b32_dpp v159, v156, v157, vcc row_ror:8 row_mask:0xf bank_mask:0xf
  v_mfma_f32_16x16x32_bf16 v[208:211], a[140:143], v[80:83], v[208:211]
  ds_read_b128 a[172:175], v243 offset:17408
  s_not_b64 vcc, vcc
  v_cndmask_b32_dpp v154, v153, v152, vcc row_ror:8 row_mask:0xf bank_mask:0xf
  v_mfma_f32_16x16x32_bf16 v[212:215], a[140:143], v[84:87], v[212:215]
  buffer_load_format_d16_xyzw v[172:173], v234, s[8:11], s45 offen
  s_waitcnt lgkmcnt(4)
  v_mfma_f32_16x16x32_bf16 v[216:219], a[144:147], v[80:83], v[216:219]
  v_add_u32 v244, 4294918144, v244
  ds_read_b128 a[128:131], v244 offset:0
  v_mfma_f32_16x16x32_bf16 v[220:223], a[144:147], v[84:87], v[220:223]
  v_cndmask_b32_dpp v158, v157, v156, vcc row_ror:8 row_mask:0xf bank_mask:0xf
  v_perm_b32 v152, v158, v154, s74
  v_mfma_f32_16x16x32_bf16 a[40:43], a[148:151], v[80:83], a[40:43]
  ds_read_b128 a[132:135], v244 offset:12288
  v_perm_b32 v156, v158, v154, s75
  v_perm_b32 v153, v159, v155, s74
  v_mfma_f32_16x16x32_bf16 a[44:47], a[148:151], v[84:87], a[44:47]
  buffer_load_format_d16_xyzw v[174:175], v235, s[8:11], s45 offen
  v_mfma_f32_16x16x32_bf16 a[48:51], a[152:155], v[80:83], a[48:51]
  ds_read_b128 a[136:139], v244 offset:1024
  v_perm_b32 v157, v159, v155, s75
  v_perm_b32 v154, v225, v224, v152
  v_mfma_f32_16x16x32_bf16 a[52:55], a[152:155], v[84:87], a[52:55]
  v_perm_b32 v158, v227, v226, v152
  v_perm_b32 v88, v158, v154, s72
  v_mfma_f32_16x16x32_bf16 a[56:59], a[156:159], v[80:83], a[56:59]
  ds_read_b128 a[140:143], v244 offset:13312
  buffer_load_format_d16_xyzw v[176:177], v232, s[8:11], s46 offen
  v_mfma_f32_16x16x32_bf16 a[60:63], a[156:159], v[84:87], a[60:63]
  v_perm_b32 v89, v158, v154, s73
  s_waitcnt lgkmcnt(4)
  v_mfma_f32_16x16x32_bf16 a[64:67], a[160:163], v[80:83], a[64:67]
  ds_read_b128 a[144:147], v244 offset:2048
  v_perm_b32 v155, v225, v224, v153
  v_perm_b32 v159, v227, v226, v153
  v_mfma_f32_16x16x32_bf16 a[68:71], a[160:163], v[84:87], a[68:71]
  v_perm_b32 v90, v159, v155, s72
  v_perm_b32 v91, v159, v155, s73
  v_mfma_f32_16x16x32_bf16 a[72:75], a[164:167], v[80:83], a[72:75]
  ds_read_b128 a[148:151], v244 offset:14336
  buffer_load_format_d16_xyzw v[178:179], v233, s[8:11], s46 offen
  v_mfma_f32_16x16x32_bf16 a[76:79], a[164:167], v[84:87], a[76:79]
  v_perm_b32 v154, v229, v228, v156
  v_perm_b32 v158, v231, v230, v156
  v_mfma_f32_16x16x32_bf16 a[80:83], a[168:171], v[80:83], a[80:83]
  ds_read_b128 a[152:155], v244 offset:3072
  v_perm_b32 v92, v158, v154, s72
  v_perm_b32 v93, v158, v154, s73
  v_mfma_f32_16x16x32_bf16 a[84:87], a[168:171], v[84:87], a[84:87]
  buffer_load_format_d16_xyzw v[180:181], v234, s[8:11], s46 offen
  v_mfma_f32_16x16x32_bf16 a[88:91], a[172:175], v[80:83], a[88:91]
  ds_read_b128 a[156:159], v244 offset:15360
  v_perm_b32 v155, v229, v228, v157
  v_perm_b32 v159, v231, v230, v157
  v_mfma_f32_16x16x32_bf16 a[92:95], a[172:175], v[84:87], a[92:95]
  v_perm_b32 v94, v159, v155, s72
  v_perm_b32 v95, v159, v155, s73
  s_waitcnt lgkmcnt(4)
  v_mfma_f32_16x16x32_bf16 v[184:187], a[128:131], v[88:91], v[184:187]
  ds_read_b128 a[160:163], v244 offset:4096
  buffer_load_format_d16_xyzw v[182:183], v235, s[8:11], s46 offen
  v_mfma_f32_16x16x32_bf16 v[188:191], a[128:131], v[92:95], v[188:191]
  s_waitcnt vmcnt(14)
  v_lshl_or_b32 v160, v162, 8, v160
  v_mfma_f32_16x16x32_bf16 v[192:195], a[132:135], v[88:91], v[192:195]
  ds_read_b128 a[164:167], v244 offset:16384
  v_lshl_or_b32 v161, v163, 8, v161
  v_mfma_f32_16x16x32_bf16 v[196:199], a[132:135], v[92:95], v[196:199]
  s_add_u32 m0, s70, 49152
  v_lshl_or_b32 v164, v166, 8, v164
  v_lshl_or_b32 v165, v167, 8, v165
  v_mfma_f32_16x16x32_bf16 v[200:203], a[136:139], v[88:91], v[200:203]
  ds_read_b128 a[168:171], v244 offset:5120
  buffer_load_dwordx4 v236, s[4:7], s57 offen offset:0  lds
  v_mfma_f32_16x16x32_bf16 v[204:207], a[136:139], v[92:95], v[204:207]
  v_cndmask_b32_dpp v162, v161, v160, vcc row_ror:8 row_mask:0xf bank_mask:0xf
  v_cndmask_b32_dpp v166, v165, v164, vcc row_ror:8 row_mask:0xf bank_mask:0xf
  v_mfma_f32_16x16x32_bf16 v[208:211], a[140:143], v[88:91], v[208:211]
  ds_read_b128 a[172:175], v244 offset:17408
  s_not_b64 vcc, vcc
  v_cndmask_b32_dpp v163, v160, v161, vcc row_ror:8 row_mask:0xf bank_mask:0xf
  v_mfma_f32_16x16x32_bf16 v[212:215], a[140:143], v[92:95], v[212:215]
  buffer_load_dwordx4 v237, s[4:7], s57 offen offset:1024  lds
  s_waitcnt lgkmcnt(4)
  v_mfma_f32_16x16x32_bf16 v[216:219], a[144:147], v[88:91], v[216:219]
  s_waitcnt vmcnt(10)
  s_barrier
  ds_read_b128 a[128:131], v243 offset:24576
  v_mfma_f32_16x16x32_bf16 v[220:223], a[144:147], v[92:95], v[220:223]
  v_cndmask_b32_dpp v167, v164, v165, vcc row_ror:8 row_mask:0xf bank_mask:0xf
  v_perm_b32 v160, v166, v162, s74
  v_mfma_f32_16x16x32_bf16 a[40:43], a[148:151], v[88:91], a[40:43]
  ds_read_b128 a[132:135], v243 offset:36864
  v_perm_b32 v164, v166, v162, s75
  v_mfma_f32_16x16x32_bf16 a[44:47], a[148:151], v[92:95], a[44:47]
  buffer_load_dwordx4 v238, s[4:7], s57 offen offset:2048  lds
  v_perm_b32 v161, v167, v163, s74
  v_mfma_f32_16x16x32_bf16 a[48:51], a[152:155], v[88:91], a[48:51]
  ds_read_b128 a[136:139], v243 offset:25600
  v_perm_b32 v165, v167, v163, s75
  v_perm_b32 v162, v225, v224, v160
  v_mfma_f32_16x16x32_bf16 a[52:55], a[152:155], v[92:95], a[52:55]
  v_perm_b32 v166, v227, v226, v160
  v_perm_b32 v96, v166, v162, s72
  v_mfma_f32_16x16x32_bf16 a[56:59], a[156:159], v[88:91], a[56:59]
  ds_read_b128 a[140:143], v243 offset:37888
  buffer_load_dwordx4 v239, s[4:7], s57 offen offset:3072  lds
  v_mfma_f32_16x16x32_bf16 a[60:63], a[156:159], v[92:95], a[60:63]
  v_perm_b32 v97, v166, v162, s73
  s_waitcnt lgkmcnt(4)
  v_mfma_f32_16x16x32_bf16 a[64:67], a[160:163], v[88:91], a[64:67]
  ds_read_b128 a[144:147], v243 offset:26624
  v_perm_b32 v163, v225, v224, v161
  v_perm_b32 v167, v227, v226, v161
  v_mfma_f32_16x16x32_bf16 a[68:71], a[160:163], v[92:95], a[68:71]
  s_add_u32 m0, s70, 53248
  v_perm_b32 v98, v167, v163, s72
  v_perm_b32 v99, v167, v163, s73
  v_mfma_f32_16x16x32_bf16 a[72:75], a[164:167], v[88:91], a[72:75]
  ds_read_b128 a[148:151], v243 offset:38912
  buffer_load_dwordx4 v240, s[4:7], s57 offen offset:0  lds
  v_mfma_f32_16x16x32_bf16 a[76:79], a[164:167], v[92:95], a[76:79]
  v_perm_b32 v162, v229, v228, v164
  v_perm_b32 v166, v231, v230, v164
  v_mfma_f32_16x16x32_bf16 a[80:83], a[168:171], v[88:91], a[80:83]
  ds_read_b128 a[152:155], v243 offset:27648
  v_perm_b32 v100, v166, v162, s72
  v_perm_b32 v101, v166, v162, s73
  v_mfma_f32_16x16x32_bf16 a[84:87], a[168:171], v[92:95], a[84:87]
  buffer_load_dwordx4 v241, s[4:7], s57 offen offset:1024  lds
  v_mfma_f32_16x16x32_bf16 a[88:91], a[172:175], v[88:91], a[88:91]
  ds_read_b128 a[156:159], v243 offset:39936
  v_perm_b32 v163, v229, v228, v165
  v_perm_b32 v167, v231, v230, v165
  v_mfma_f32_16x16x32_bf16 a[92:95], a[172:175], v[92:95], a[92:95]
  v_perm_b32 v102, v167, v163, s72
  v_perm_b32 v103, v167, v163, s73
  s_waitcnt lgkmcnt(4)
  v_mfma_f32_16x16x32_bf16 v[184:187], a[128:131], v[96:99], v[184:187]
  ds_read_b128 a[160:163], v243 offset:28672
  buffer_load_format_d16_xyzw v[144:145], v232, s[8:11], s47 offen
  v_mfma_f32_16x16x32_bf16 v[188:191], a[128:131], v[100:103], v[188:191]
  s_waitcnt vmcnt(11)
  v_lshl_or_b32 v168, v170, 8, v168
  v_mfma_f32_16x16x32_bf16 v[192:195], a[132:135], v[96:99], v[192:195]
  ds_read_b128 a[164:167], v243 offset:40960
  v_lshl_or_b32 v169, v171, 8, v169
  v_mfma_f32_16x16x32_bf16 v[196:199], a[132:135], v[100:103], v[196:199]
  v_lshl_or_b32 v172, v174, 8, v172
  v_lshl_or_b32 v173, v175, 8, v173
  v_mfma_f32_16x16x32_bf16 v[200:203], a[136:139], v[96:99], v[200:203]
  ds_read_b128 a[168:171], v243 offset:29696
  buffer_load_format_d16_xyzw v[146:147], v233, s[8:11], s47 offen
  v_mfma_f32_16x16x32_bf16 v[204:207], a[136:139], v[100:103], v[204:207]
  v_cndmask_b32_dpp v171, v168, v169, vcc row_ror:8 row_mask:0xf bank_mask:0xf
  v_cndmask_b32_dpp v175, v172, v173, vcc row_ror:8 row_mask:0xf bank_mask:0xf
  v_mfma_f32_16x16x32_bf16 v[208:211], a[140:143], v[96:99], v[208:211]
  ds_read_b128 a[172:175], v243 offset:41984
  s_not_b64 vcc, vcc
  v_cndmask_b32_dpp v170, v169, v168, vcc row_ror:8 row_mask:0xf bank_mask:0xf
  v_mfma_f32_16x16x32_bf16 v[212:215], a[140:143], v[100:103], v[212:215]
  buffer_load_format_d16_xyzw v[148:149], v234, s[8:11], s47 offen
  s_waitcnt lgkmcnt(4)
  v_mfma_f32_16x16x32_bf16 v[216:219], a[144:147], v[96:99], v[216:219]
  ds_read_b128 a[128:131], v244 offset:24576
  v_cndmask_b32_dpp v174, v173, v172, vcc row_ror:8 row_mask:0xf bank_mask:0xf
  v_mfma_f32_16x16x32_bf16 v[220:223], a[144:147], v[100:103], v[220:223]
  v_perm_b32 v168, v174, v170, s74
  v_perm_b32 v172, v174, v170, s75
  v_mfma_f32_16x16x32_bf16 a[40:43], a[148:151], v[96:99], a[40:43]
  ds_read_b128 a[132:135], v244 offset:36864
  v_perm_b32 v169, v175, v171, s74
  v_perm_b32 v173, v175, v171, s75
  v_mfma_f32_16x16x32_bf16 a[44:47], a[148:151], v[100:103], a[44:47]
  buffer_load_format_d16_xyzw v[150:151], v235, s[8:11], s47 offen
  v_mfma_f32_16x16x32_bf16 a[48:51], a[152:155], v[96:99], a[48:51]
  ds_read_b128 a[136:139], v244 offset:25600
  v_perm_b32 v170, v225, v224, v168
  v_mfma_f32_16x16x32_bf16 a[52:55], a[152:155], v[100:103], a[52:55]
  v_perm_b32 v174, v227, v226, v168
  v_perm_b32 v104, v174, v170, s72
  v_perm_b32 v105, v174, v170, s73
  v_mfma_f32_16x16x32_bf16 a[56:59], a[156:159], v[96:99], a[56:59]
  ds_read_b128 a[140:143], v244 offset:37888
  buffer_load_format_d16_xyzw v[152:153], v232, s[8:11], s48 offen
  v_mfma_f32_16x16x32_bf16 a[60:63], a[156:159], v[100:103], a[60:63]
  v_perm_b32 v171, v225, v224, v169
  s_waitcnt lgkmcnt(4)
  v_mfma_f32_16x16x32_bf16 a[64:67], a[160:163], v[96:99], a[64:67]
  ds_read_b128 a[144:147], v244 offset:26624
  v_perm_b32 v175, v227, v226, v169
  v_mfma_f32_16x16x32_bf16 a[68:71], a[160:163], v[100:103], a[68:71]
  v_perm_b32 v106, v175, v171, s72
  v_perm_b32 v107, v175, v171, s73
  v_perm_b32 v170, v229, v228, v172
  v_mfma_f32_16x16x32_bf16 a[72:75], a[164:167], v[96:99], a[72:75]
  ds_read_b128 a[148:151], v244 offset:38912
  buffer_load_format_d16_xyzw v[154:155], v233, s[8:11], s48 offen
  v_mfma_f32_16x16x32_bf16 a[76:79], a[164:167], v[100:103], a[76:79]
  v_perm_b32 v174, v231, v230, v172
  v_perm_b32 v108, v174, v170, s72
  v_mfma_f32_16x16x32_bf16 a[80:83], a[168:171], v[96:99], a[80:83]
  ds_read_b128 a[152:155], v244 offset:27648
  v_perm_b32 v109, v174, v170, s73
  v_mfma_f32_16x16x32_bf16 a[84:87], a[168:171], v[100:103], a[84:87]
  buffer_load_format_d16_xyzw v[156:157], v234, s[8:11], s48 offen
  v_perm_b32 v171, v229, v228, v173
  v_mfma_f32_16x16x32_bf16 a[88:91], a[172:175], v[96:99], a[88:91]
  ds_read_b128 a[156:159], v244 offset:39936
  v_perm_b32 v175, v231, v230, v173
  v_mfma_f32_16x16x32_bf16 a[92:95], a[172:175], v[100:103], a[92:95]
  v_perm_b32 v110, v175, v171, s72
  v_perm_b32 v111, v175, v171, s73
  s_waitcnt lgkmcnt(4)
  v_mfma_f32_16x16x32_bf16 v[184:187], a[128:131], v[104:107], v[184:187]
  ds_read_b128 a[160:163], v244 offset:28672
  buffer_load_format_d16_xyzw v[158:159], v235, s[8:11], s48 offen
  v_mfma_f32_16x16x32_bf16 v[188:191], a[128:131], v[108:111], v[188:191]
  s_waitcnt vmcnt(14)
  v_lshl_or_b32 v176, v178, 8, v176
  v_mfma_f32_16x16x32_bf16 v[192:195], a[132:135], v[104:107], v[192:195]
  ds_read_b128 a[164:167], v244 offset:40960
  v_lshl_or_b32 v177, v179, 8, v177
  v_mfma_f32_16x16x32_bf16 v[196:199], a[132:135], v[108:111], v[196:199]
  s_add_u32 m0, s70, 73728
  v_lshl_or_b32 v180, v182, 8, v180
  v_lshl_or_b32 v181, v183, 8, v181
  v_mfma_f32_16x16x32_bf16 v[200:203], a[136:139], v[104:107], v[200:203]
  ds_read_b128 a[168:171], v244 offset:29696
  buffer_load_dwordx4 v236, s[4:7], s58 offen offset:0  lds
  v_mfma_f32_16x16x32_bf16 v[204:207], a[136:139], v[108:111], v[204:207]
  v_cndmask_b32_dpp v178, v177, v176, vcc row_ror:8 row_mask:0xf bank_mask:0xf
  v_cndmask_b32_dpp v182, v181, v180, vcc row_ror:8 row_mask:0xf bank_mask:0xf
  v_mfma_f32_16x16x32_bf16 v[208:211], a[140:143], v[104:107], v[208:211]
  ds_read_b128 a[172:175], v244 offset:41984
  s_not_b64 vcc, vcc
  v_cndmask_b32_dpp v179, v176, v177, vcc row_ror:8 row_mask:0xf bank_mask:0xf
  v_mfma_f32_16x16x32_bf16 v[212:215], a[140:143], v[108:111], v[212:215]
  buffer_load_dwordx4 v237, s[4:7], s58 offen offset:1024  lds
  s_waitcnt lgkmcnt(4)
  v_mfma_f32_16x16x32_bf16 v[216:219], a[144:147], v[104:107], v[216:219]
  s_waitcnt vmcnt(10)
  s_barrier
  ds_read_b128 a[128:131], v243 offset:49152
  v_mfma_f32_16x16x32_bf16 v[220:223], a[144:147], v[108:111], v[220:223]
  v_cndmask_b32_dpp v183, v180, v181, vcc row_ror:8 row_mask:0xf bank_mask:0xf
  v_perm_b32 v176, v182, v178, s74
  v_mfma_f32_16x16x32_bf16 a[40:43], a[148:151], v[104:107], a[40:43]
  ds_read_b128 a[132:135], v243 offset:61440
  v_perm_b32 v180, v182, v178, s75
  v_mfma_f32_16x16x32_bf16 a[44:47], a[148:151], v[108:111], a[44:47]
  buffer_load_dwordx4 v238, s[4:7], s58 offen offset:2048  lds
  v_perm_b32 v177, v183, v179, s74
  v_mfma_f32_16x16x32_bf16 a[48:51], a[152:155], v[104:107], a[48:51]
  ds_read_b128 a[136:139], v243 offset:50176
  v_perm_b32 v181, v183, v179, s75
  v_perm_b32 v178, v225, v224, v176
  v_mfma_f32_16x16x32_bf16 a[52:55], a[152:155], v[108:111], a[52:55]
  v_perm_b32 v182, v227, v226, v176
  v_perm_b32 v112, v182, v178, s72
  v_mfma_f32_16x16x32_bf16 a[56:59], a[156:159], v[104:107], a[56:59]
  ds_read_b128 a[140:143], v243 offset:62464
  buffer_load_dwordx4 v239, s[4:7], s58 offen offset:3072  lds
  v_mfma_f32_16x16x32_bf16 a[60:63], a[156:159], v[108:111], a[60:63]
  v_perm_b32 v113, v182, v178, s73
  s_waitcnt lgkmcnt(4)
  v_mfma_f32_16x16x32_bf16 a[64:67], a[160:163], v[104:107], a[64:67]
  ds_read_b128 a[144:147], v243 offset:51200
  v_perm_b32 v179, v225, v224, v177
  v_perm_b32 v183, v227, v226, v177
  v_mfma_f32_16x16x32_bf16 a[68:71], a[160:163], v[108:111], a[68:71]
  s_add_u32 m0, s70, 77824
  v_perm_b32 v114, v183, v179, s72
  v_perm_b32 v115, v183, v179, s73
  v_mfma_f32_16x16x32_bf16 a[72:75], a[164:167], v[104:107], a[72:75]
  ds_read_b128 a[148:151], v243 offset:63488
  buffer_load_dwordx4 v240, s[4:7], s58 offen offset:0  lds
  v_mfma_f32_16x16x32_bf16 a[76:79], a[164:167], v[108:111], a[76:79]
  v_perm_b32 v178, v229, v228, v180
  v_perm_b32 v182, v231, v230, v180
  v_mfma_f32_16x16x32_bf16 a[80:83], a[168:171], v[104:107], a[80:83]
  ds_read_b128 a[152:155], v243 offset:52224
  v_perm_b32 v116, v182, v178, s72
  v_perm_b32 v117, v182, v178, s73
  v_mfma_f32_16x16x32_bf16 a[84:87], a[168:171], v[108:111], a[84:87]
  buffer_load_dwordx4 v241, s[4:7], s58 offen offset:1024  lds
  v_mfma_f32_16x16x32_bf16 a[88:91], a[172:175], v[104:107], a[88:91]
  ds_read_b128 a[156:159], v243 offset:64512
  v_perm_b32 v179, v229, v228, v181
  v_perm_b32 v183, v231, v230, v181
  v_mfma_f32_16x16x32_bf16 a[92:95], a[172:175], v[108:111], a[92:95]
  v_perm_b32 v118, v183, v179, s72
  v_perm_b32 v119, v183, v179, s73
  s_waitcnt lgkmcnt(4)
  v_mfma_f32_16x16x32_bf16 v[184:187], a[128:131], v[112:115], v[184:187]
  ds_read_b128 a[160:163], v243 offset:53248
  buffer_load_format_d16_xyzw v[160:161], v232, s[8:11], s49 offen
  v_mfma_f32_16x16x32_bf16 v[188:191], a[128:131], v[116:119], v[188:191]
  s_waitcnt vmcnt(11)
  v_lshl_or_b32 v144, v146, 8, v144
  v_mfma_f32_16x16x32_bf16 v[192:195], a[132:135], v[112:115], v[192:195]
  v_add_u32 v243, 49152, v243
  ds_read_b128 a[164:167], v243 offset:16384
  v_mfma_f32_16x16x32_bf16 v[196:199], a[132:135], v[116:119], v[196:199]
  v_lshl_or_b32 v145, v147, 8, v145
  v_lshl_or_b32 v148, v150, 8, v148
  v_lshl_or_b32 v149, v151, 8, v149
  v_mfma_f32_16x16x32_bf16 v[200:203], a[136:139], v[112:115], v[200:203]
  ds_read_b128 a[168:171], v243 offset:5120
  buffer_load_format_d16_xyzw v[162:163], v233, s[8:11], s49 offen
  v_mfma_f32_16x16x32_bf16 v[204:207], a[136:139], v[116:119], v[204:207]
  v_cndmask_b32_dpp v147, v144, v145, vcc row_ror:8 row_mask:0xf bank_mask:0xf
  v_cndmask_b32_dpp v151, v148, v149, vcc row_ror:8 row_mask:0xf bank_mask:0xf
  v_mfma_f32_16x16x32_bf16 v[208:211], a[140:143], v[112:115], v[208:211]
  ds_read_b128 a[172:175], v243 offset:17408
  s_not_b64 vcc, vcc
  v_mfma_f32_16x16x32_bf16 v[212:215], a[140:143], v[116:119], v[212:215]
  buffer_load_format_d16_xyzw v[164:165], v234, s[8:11], s49 offen
  s_waitcnt lgkmcnt(4)
  v_mfma_f32_16x16x32_bf16 v[216:219], a[144:147], v[112:115], v[216:219]
  ds_read_b128 a[128:131], v244 offset:49152
  v_cndmask_b32_dpp v146, v145, v144, vcc row_ror:8 row_mask:0xf bank_mask:0xf
  v_mfma_f32_16x16x32_bf16 v[220:223], a[144:147], v[116:119], v[220:223]
  v_cndmask_b32_dpp v150, v149, v148, vcc row_ror:8 row_mask:0xf bank_mask:0xf
  v_perm_b32 v144, v150, v146, s74
  v_perm_b32 v148, v150, v146, s75
  v_mfma_f32_16x16x32_bf16 a[40:43], a[148:151], v[112:115], a[40:43]
  ds_read_b128 a[132:135], v244 offset:61440
  v_perm_b32 v145, v151, v147, s74
  v_mfma_f32_16x16x32_bf16 a[44:47], a[148:151], v[116:119], a[44:47]
  buffer_load_format_d16_xyzw v[166:167], v235, s[8:11], s49 offen
  v_perm_b32 v149, v151, v147, s75
  v_mfma_f32_16x16x32_bf16 a[48:51], a[152:155], v[112:115], a[48:51]
  ds_read_b128 a[136:139], v244 offset:50176
  v_perm_b32 v146, v225, v224, v144
  v_perm_b32 v150, v227, v226, v144
  v_mfma_f32_16x16x32_bf16 a[52:55], a[152:155], v[116:119], a[52:55]
  s_add_u32 m0, s71, 98304
  v_perm_b32 v120, v150, v146, s72
  v_mfma_f32_16x16x32_bf16 a[56:59], a[156:159], v[112:115], a[56:59]
  ds_read_b128 a[140:143], v244 offset:62464
  buffer_load_dwordx4 v247, s[4:7], s60 offen offset:0  lds
  v_mfma_f32_16x16x32_bf16 a[60:63], a[156:159], v[116:119], a[60:63]
  v_perm_b32 v121, v150, v146, s73
  s_waitcnt lgkmcnt(4)
  v_mfma_f32_16x16x32_bf16 a[64:67], a[160:163], v[112:115], a[64:67]
  ds_read_b128 a[144:147], v244 offset:51200
  v_perm_b32 v147, v225, v224, v145
  v_perm_b32 v151, v227, v226, v145
  v_mfma_f32_16x16x32_bf16 a[68:71], a[160:163], v[116:119], a[68:71]
  v_perm_b32 v122, v151, v147, s72
  v_perm_b32 v123, v151, v147, s73
  v_mfma_f32_16x16x32_bf16 a[72:75], a[164:167], v[112:115], a[72:75]
  ds_read_b128 a[148:151], v244 offset:63488
  buffer_load_dwordx4 v247, s[4:7], s61 offen offset:1024  lds
  v_mfma_f32_16x16x32_bf16 a[76:79], a[164:167], v[116:119], a[76:79]
  v_perm_b32 v146, v229, v228, v148
  v_perm_b32 v150, v231, v230, v148
  v_mfma_f32_16x16x32_bf16 a[80:83], a[168:171], v[112:115], a[80:83]
  ds_read_b128 a[152:155], v244 offset:52224
  v_perm_b32 v124, v150, v146, s72
  v_perm_b32 v125, v150, v146, s73
  v_mfma_f32_16x16x32_bf16 a[84:87], a[168:171], v[116:119], a[84:87]
  buffer_load_dwordx4 v247, s[4:7], s62 offen offset:2048  lds
  v_mfma_f32_16x16x32_bf16 a[88:91], a[172:175], v[112:115], a[88:91]
  ds_read_b128 a[156:159], v244 offset:64512
  v_perm_b32 v147, v229, v228, v149
  v_perm_b32 v151, v231, v230, v149
  v_mfma_f32_16x16x32_bf16 a[92:95], a[172:175], v[116:119], a[92:95]
  v_perm_b32 v126, v151, v147, s72
  v_perm_b32 v127, v151, v147, s73
  s_waitcnt lgkmcnt(4)
  v_mfma_f32_16x16x32_bf16 v[184:187], a[128:131], v[120:123], v[184:187]
  ds_read_b128 a[160:163], v244 offset:53248
  buffer_load_dwordx4 v247, s[4:7], s63 offen offset:3072  lds
  v_mfma_f32_16x16x32_bf16 v[188:191], a[128:131], v[124:127], v[188:191]
  s_waitcnt vmcnt(14)
  v_lshl_or_b32 v152, v154, 8, v152
  v_mfma_f32_16x16x32_bf16 v[192:195], a[132:135], v[120:123], v[192:195]
  v_add_u32 v244, 49152, v244
  ds_read_b128 a[164:167], v244 offset:16384
  v_lshl_or_b32 v153, v155, 8, v153
  v_mfma_f32_16x16x32_bf16 v[196:199], a[132:135], v[124:127], v[196:199]
  s_add_u32 m0, s71, 102400
  v_lshl_or_b32 v156, v158, 8, v156
  v_mfma_f32_16x16x32_bf16 v[200:203], a[136:139], v[120:123], v[200:203]
  ds_read_b128 a[168:171], v244 offset:5120
  buffer_load_dwordx4 v247, s[4:7], s64 offen offset:0  lds
  v_mfma_f32_16x16x32_bf16 v[204:207], a[136:139], v[124:127], v[204:207]
  v_lshl_or_b32 v157, v159, 8, v157
  v_cndmask_b32_dpp v154, v153, v152, vcc row_ror:8 row_mask:0xf bank_mask:0xf
  s_nop 0
  v_cndmask_b32_dpp v158, v157, v156, vcc row_ror:8 row_mask:0xf bank_mask:0xf
  v_mfma_f32_16x16x32_bf16 v[208:211], a[140:143], v[120:123], v[208:211]
  ds_read_b128 a[172:175], v244 offset:17408
  s_not_b64 vcc, vcc
  v_mfma_f32_16x16x32_bf16 v[212:215], a[140:143], v[124:127], v[212:215]
  buffer_load_dwordx4 v247, s[4:7], s65 offen offset:1024  lds
  s_waitcnt lgkmcnt(4)
  v_mfma_f32_16x16x32_bf16 v[216:219], a[144:147], v[120:123], v[216:219]
  s_waitcnt vmcnt(10)
  s_barrier
  ds_read_b128 a[128:131], v243 offset:24576
  v_mfma_f32_16x16x32_bf16 v[220:223], a[144:147], v[124:127], v[220:223]
  v_cndmask_b32_dpp v155, v152, v153, vcc row_ror:8 row_mask:0xf bank_mask:0xf
  v_cndmask_b32_dpp v159, v156, v157, vcc row_ror:8 row_mask:0xf bank_mask:0xf
  v_mfma_f32_16x16x32_bf16 a[40:43], a[148:151], v[120:123], a[40:43]
  ds_read_b128 a[132:135], v243 offset:36864
  v_perm_b32 v152, v158, v154, s74
  v_perm_b32 v156, v158, v154, s75
  v_mfma_f32_16x16x32_bf16 a[44:47], a[148:151], v[124:127], a[44:47]
  buffer_load_dwordx4 v247, s[4:7], s66 offen offset:2048  lds
  v_perm_b32 v153, v159, v155, s74
  v_mfma_f32_16x16x32_bf16 a[48:51], a[152:155], v[120:123], a[48:51]
  ds_read_b128 a[136:139], v243 offset:25600
  v_perm_b32 v157, v159, v155, s75
  v_perm_b32 v154, v225, v224, v152
  v_mfma_f32_16x16x32_bf16 a[52:55], a[152:155], v[124:127], a[52:55]
  v_perm_b32 v158, v227, v226, v152
  v_perm_b32 v128, v158, v154, s72
  v_mfma_f32_16x16x32_bf16 a[56:59], a[156:159], v[120:123], a[56:59]
  ds_read_b128 a[140:143], v243 offset:37888
  buffer_load_dwordx4 v247, s[4:7], s67 offen offset:3072  lds
  v_mfma_f32_16x16x32_bf16 a[60:63], a[156:159], v[124:127], a[60:63]
  v_perm_b32 v129, v158, v154, s73
  v_perm_b32 v155, v225, v224, v153
  s_waitcnt lgkmcnt(4)
  v_mfma_f32_16x16x32_bf16 a[64:67], a[160:163], v[120:123], a[64:67]
  ds_read_b128 a[144:147], v243 offset:26624
  v_perm_b32 v159, v227, v226, v153
  v_mfma_f32_16x16x32_bf16 a[68:71], a[160:163], v[124:127], a[68:71]
  s_add_u32 m0, s71, 106496
  v_perm_b32 v130, v159, v155, s72
  v_perm_b32 v131, v159, v155, s73
  v_mfma_f32_16x16x32_bf16 a[72:75], a[164:167], v[120:123], a[72:75]
  ds_read_b128 a[148:151], v243 offset:38912
  buffer_load_dwordx4 v247, s[4:7], s68 offen offset:0  lds
  v_mfma_f32_16x16x32_bf16 a[76:79], a[164:167], v[124:127], a[76:79]
  v_perm_b32 v154, v229, v228, v156
  v_perm_b32 v158, v231, v230, v156
  v_perm_b32 v132, v158, v154, s72
  v_mfma_f32_16x16x32_bf16 a[80:83], a[168:171], v[120:123], a[80:83]
  ds_read_b128 a[152:155], v243 offset:27648
  s_add_u32 m0, s30, 135168
  v_mfma_f32_16x16x32_bf16 a[84:87], a[168:171], v[124:127], a[84:87]
  buffer_load_dwordx4 v254, s[4:7], s60 offen offset:0  lds
  v_perm_b32 v133, v158, v154, s73
  v_mfma_f32_16x16x32_bf16 a[88:91], a[172:175], v[120:123], a[88:91]
  ds_read_b128 a[156:159], v243 offset:39936
  v_perm_b32 v155, v229, v228, v157
  v_perm_b32 v159, v231, v230, v157
  v_mfma_f32_16x16x32_bf16 a[92:95], a[172:175], v[124:127], a[92:95]
  v_perm_b32 v134, v159, v155, s72
  v_perm_b32 v135, v159, v155, s73
  s_waitcnt lgkmcnt(4)
  v_mfma_f32_16x16x32_bf16 v[184:187], a[128:131], v[128:131], v[184:187]
  ds_read_b128 a[160:163], v243 offset:28672
  buffer_load_dwordx4 v254, s[4:7], s61 offen offset:1024  lds
  v_mfma_f32_16x16x32_bf16 v[188:191], a[128:131], v[132:135], v[188:191]
  s_waitcnt vmcnt(11)
  v_lshl_or_b32 v160, v162, 8, v160
  v_mfma_f32_16x16x32_bf16 v[192:195], a[132:135], v[128:131], v[192:195]
  ds_read_b128 a[164:167], v243 offset:40960
  v_lshl_or_b32 v161, v163, 8, v161
  v_mfma_f32_16x16x32_bf16 v[196:199], a[132:135], v[132:135], v[196:199]
  v_lshl_or_b32 v164, v166, 8, v164
  v_lshl_or_b32 v165, v167, 8, v165
  v_cndmask_b32_dpp v163, v160, v161, vcc row_ror:8 row_mask:0xf bank_mask:0xf
  v_mfma_f32_16x16x32_bf16 v[200:203], a[136:139], v[128:131], v[200:203]
  ds_read_b128 a[168:171], v243 offset:29696
  buffer_load_dwordx4 v254, s[4:7], s62 offen offset:2048  lds
  v_mfma_f32_16x16x32_bf16 v[204:207], a[136:139], v[132:135], v[204:207]
  v_cndmask_b32_dpp v167, v164, v165, vcc row_ror:8 row_mask:0xf bank_mask:0xf
  s_not_b64 vcc, vcc
  v_mfma_f32_16x16x32_bf16 v[208:211], a[140:143], v[128:131], v[208:211]
  ds_read_b128 a[172:175], v243 offset:41984
  v_cndmask_b32_dpp v162, v161, v160, vcc row_ror:8 row_mask:0xf bank_mask:0xf
  v_mfma_f32_16x16x32_bf16 v[212:215], a[140:143], v[132:135], v[212:215]
  buffer_load_dwordx4 v254, s[4:7], s63 offen offset:3072  lds
  s_waitcnt lgkmcnt(4)
  v_mfma_f32_16x16x32_bf16 v[216:219], a[144:147], v[128:131], v[216:219]
  ds_read_b128 a[128:131], v244 offset:24576
  v_cndmask_b32_dpp v166, v165, v164, vcc row_ror:8 row_mask:0xf bank_mask:0xf
  v_mfma_f32_16x16x32_bf16 v[220:223], a[144:147], v[132:135], v[220:223]
  v_perm_b32 v160, v166, v162, s74
  v_perm_b32 v164, v166, v162, s75
  v_perm_b32 v161, v167, v163, s74
  v_mfma_f32_16x16x32_bf16 a[40:43], a[148:151], v[128:131], a[40:43]
  ds_read_b128 a[132:135], v244 offset:36864
  s_add_u32 m0, s30, 139264
  v_mfma_f32_16x16x32_bf16 a[44:47], a[148:151], v[132:135], a[44:47]
  buffer_load_dwordx4 v254, s[4:7], s64 offen offset:0  lds
  v_perm_b32 v165, v167, v163, s75
  v_mfma_f32_16x16x32_bf16 a[48:51], a[152:155], v[128:131], a[48:51]
  ds_read_b128 a[136:139], v244 offset:25600
  v_perm_b32 v162, v225, v224, v160
  v_perm_b32 v166, v227, v226, v160
  v_mfma_f32_16x16x32_bf16 a[52:55], a[152:155], v[132:135], a[52:55]
  v_perm_b32 v136, v166, v162, s72
  v_perm_b32 v137, v166, v162, s73
  v_mfma_f32_16x16x32_bf16 a[56:59], a[156:159], v[128:131], a[56:59]
  ds_read_b128 a[140:143], v244 offset:37888
  buffer_load_dwordx4 v254, s[4:7], s65 offen offset:1024  lds
  v_mfma_f32_16x16x32_bf16 a[60:63], a[156:159], v[132:135], a[60:63]
  v_perm_b32 v163, v225, v224, v161
  s_waitcnt lgkmcnt(4)
  v_mfma_f32_16x16x32_bf16 a[64:67], a[160:163], v[128:131], a[64:67]
  ds_read_b128 a[144:147], v244 offset:26624
  v_perm_b32 v167, v227, v226, v161
  v_perm_b32 v138, v167, v163, s72
  v_mfma_f32_16x16x32_bf16 a[68:71], a[160:163], v[132:135], a[68:71]
  v_perm_b32 v139, v167, v163, s73
  v_perm_b32 v162, v229, v228, v164
  v_mfma_f32_16x16x32_bf16 a[72:75], a[164:167], v[128:131], a[72:75]
  ds_read_b128 a[148:151], v244 offset:38912
  buffer_load_dwordx4 v254, s[4:7], s66 offen offset:2048  lds
  v_mfma_f32_16x16x32_bf16 a[76:79], a[164:167], v[132:135], a[76:79]
  v_perm_b32 v166, v231, v230, v164
  v_perm_b32 v140, v166, v162, s72
  v_mfma_f32_16x16x32_bf16 a[80:83], a[168:171], v[128:131], a[80:83]
  ds_read_b128 a[152:155], v244 offset:27648
  v_perm_b32 v141, v166, v162, s73
  v_perm_b32 v163, v229, v228, v165
  v_mfma_f32_16x16x32_bf16 a[84:87], a[168:171], v[132:135], a[84:87]
  buffer_load_dwordx4 v254, s[4:7], s67 offen offset:3072  lds
  v_mfma_f32_16x16x32_bf16 a[88:91], a[172:175], v[128:131], a[88:91]
  ds_read_b128 a[156:159], v244 offset:39936
  v_perm_b32 v167, v231, v230, v165
  v_perm_b32 v142, v167, v163, s72
  v_mfma_f32_16x16x32_bf16 a[92:95], a[172:175], v[132:135], a[92:95]
  s_add_u32 m0, s30, 143360
  v_perm_b32 v143, v167, v163, s73
  s_waitcnt lgkmcnt(4)
  v_mfma_f32_16x16x32_bf16 v[184:187], a[128:131], v[136:139], v[184:187]
  ds_read_b128 a[160:163], v244 offset:28672
  buffer_load_dwordx4 v254, s[4:7], s68 offen offset:0  lds
  v_mfma_f32_16x16x32_bf16 v[188:191], a[128:131], v[140:143], v[188:191]
  v_mfma_f32_16x16x32_bf16 v[192:195], a[132:135], v[136:139], v[192:195]
  ds_read_b128 a[164:167], v244 offset:40960
  v_mfma_f32_16x16x32_bf16 v[196:199], a[132:135], v[140:143], v[196:199]
  v_add_u32 v247, s96, v247
  s_add_u32 m0, s71, 0
  v_mfma_f32_16x16x32_bf16 v[200:203], a[136:139], v[136:139], v[200:203]
  ds_read_b128 a[168:171], v244 offset:29696
  buffer_load_dwordx4 v247, s[4:7], s60 offen offset:0  lds
  v_mfma_f32_16x16x32_bf16 v[204:207], a[136:139], v[140:143], v[204:207]
  v_mfma_f32_16x16x32_bf16 v[208:211], a[140:143], v[136:139], v[208:211]
  ds_read_b128 a[172:175], v244 offset:41984
  v_cvt_pk_bf16_f32 v160, v184, v188
  v_mfma_f32_16x16x32_bf16 v[212:215], a[140:143], v[140:143], v[212:215]
  buffer_load_dwordx4 v247, s[4:7], s61 offen offset:1024  lds
  s_waitcnt lgkmcnt(4)
  v_mfma_f32_16x16x32_bf16 v[216:219], a[144:147], v[136:139], v[216:219]
  s_waitcnt vmcnt(11)
  s_barrier
  v_add_u32 v245, 98304, v245
  ds_read_b128 a[128:131], v245 offset:0
  v_mfma_f32_16x16x32_bf16 v[220:223], a[144:147], v[140:143], v[220:223]
  v_cvt_pk_bf16_f32 v161, v185, v189
  v_cvt_pk_bf16_f32 v162, v186, v190
  v_mfma_f32_16x16x32_bf16 a[40:43], a[148:151], v[136:139], a[40:43]
  v_add_u32 v246, 98304, v246
  ds_read_b128 a[132:135], v246 offset:0
  v_mfma_f32_16x16x32_bf16 a[44:47], a[148:151], v[140:143], a[44:47]
  buffer_load_dwordx4 v247, s[4:7], s62 offen offset:2048  lds
  v_mfma_f32_16x16x32_bf16 a[48:51], a[152:155], v[136:139], a[48:51]
  ds_read_b128 a[136:139], v245 offset:1024
  v_cvt_pk_bf16_f32 v163, v187, v191
  v_mfma_f32_16x16x32_bf16 a[52:55], a[152:155], v[140:143], a[52:55]
  v_cndmask_b32_dpp v164, v161, v160, vcc row_ror:8 row_mask:0xf bank_mask:0xf
  v_cndmask_b32_dpp v166, v163, v162, vcc row_ror:8 row_mask:0xf bank_mask:0xf
  v_mfma_f32_16x16x32_bf16 a[56:59], a[156:159], v[136:139], a[56:59]
  ds_read_b128 a[140:143], v246 offset:1024
  buffer_load_dwordx4 v247, s[4:7], s63 offen offset:3072  lds
  v_mfma_f32_16x16x32_bf16 a[60:63], a[156:159], v[140:143], a[60:63]
  s_not_b64 vcc, vcc
  s_waitcnt lgkmcnt(4)
  v_mfma_f32_16x16x32_bf16 a[64:67], a[160:163], v[136:139], a[64:67]
  ds_read_b128 a[144:147], v245 offset:2048
  v_cndmask_b32_dpp v165, v160, v161, vcc row_ror:8 row_mask:0xf bank_mask:0xf
  v_mfma_f32_16x16x32_bf16 a[68:71], a[160:163], v[140:143], a[68:71]
  s_add_u32 m0, s71, 4096
  v_cndmask_b32_dpp v167, v162, v163, vcc row_ror:8 row_mask:0xf bank_mask:0xf
  v_mfma_f32_16x16x32_bf16 a[72:75], a[164:167], v[136:139], a[72:75]
  ds_read_b128 a[148:151], v246 offset:2048
  buffer_load_dwordx4 v247, s[4:7], s64 offen offset:0  lds
  v_mfma_f32_16x16x32_bf16 a[76:79], a[164:167], v[140:143], a[76:79]
  v_mfma_f32_16x16x32_bf16 a[80:83], a[168:171], v[136:139], a[80:83]
  ds_read_b128 a[152:155], v245 offset:3072
  v_mfma_f32_16x16x32_bf16 a[84:87], a[168:171], v[140:143], a[84:87]
  buffer_load_dwordx4 v247, s[4:7], s65 offen offset:1024  lds
  v_mfma_f32_16x16x32_bf16 a[88:91], a[172:175], v[136:139], a[88:91]
  ds_read_b128 a[156:159], v246 offset:3072
  v_mfma_f32_16x16x32_bf16 a[92:95], a[172:175], v[140:143], a[92:95]
  s_waitcnt lgkmcnt(4)
  v_mfma_f32_16x16x32_bf16 v[144:147], a[128:131], v[0:3], 0
  ds_read_b128 a[160:163], v245 offset:4096
  v_mfma_f32_16x16x32_bf16 v[148:151], a[128:131], v[4:7], 0
  buffer_load_dwordx4 v247, s[4:7], s66 offen offset:2048  lds
  v_mfma_f32_16x16x32_bf16 v[144:147], a[132:135], v[8:11], v[144:147]
  ds_read_b128 a[164:167], v246 offset:4096
  v_mfma_f32_16x16x32_bf16 v[148:151], a[132:135], v[12:15], v[148:151]
  v_mfma_f32_16x16x32_bf16 v[144:147], a[136:139], v[16:19], v[144:147]
  ds_read_b128 a[168:171], v245 offset:5120
  v_mfma_f32_16x16x32_bf16 v[148:151], a[136:139], v[20:23], v[148:151]
  buffer_load_dwordx4 v247, s[4:7], s67 offen offset:3072  lds
  v_mfma_f32_16x16x32_bf16 v[144:147], a[140:143], v[24:27], v[144:147]
  ds_read_b128 a[172:175], v246 offset:5120
  v_mfma_f32_16x16x32_bf16 v[148:151], a[140:143], v[28:31], v[148:151]
  s_waitcnt lgkmcnt(4)
  v_mfma_f32_16x16x32_bf16 v[144:147], a[144:147], v[32:35], v[144:147]
  ds_read_b128 a[128:131], v245 offset:6144
  s_add_u32 m0, s71, 8192
  v_mfma_f32_16x16x32_bf16 v[148:151], a[144:147], v[36:39], v[148:151]
  buffer_load_dwordx4 v247, s[4:7], s68 offen offset:0  lds
  v_mfma_f32_16x16x32_bf16 v[144:147], a[148:151], v[40:43], v[144:147]
  ds_read_b128 a[132:135], v246 offset:6144
  v_mfma_f32_16x16x32_bf16 v[148:151], a[148:151], v[44:47], v[148:151]
  v_mfma_f32_16x16x32_bf16 v[144:147], a[152:155], v[48:51], v[144:147]
  ds_read_b128 a[136:139], v245 offset:7168
  v_add_u32 v247, s97, v247
  s_add_u32 m0, s71, 36864
  v_mfma_f32_16x16x32_bf16 v[148:151], a[152:155], v[52:55], v[148:151]
  buffer_load_dwordx4 v247, s[4:7], s60 offen offset:0  lds
  v_mfma_f32_16x16x32_bf16 v[144:147], a[156:159], v[56:59], v[144:147]
  ds_read_b128 a[140:143], v246 offset:7168
  v_mfma_f32_16x16x32_bf16 v[148:151], a[156:159], v[60:63], v[148:151]
  s_waitcnt lgkmcnt(4)
  v_mfma_f32_16x16x32_bf16 v[144:147], a[160:163], v[64:67], v[144:147]
  ds_read_b128 a[144:147], v245 offset:8192
  v_mfma_f32_16x16x32_bf16 v[148:151], a[160:163], v[68:71], v[148:151]
  buffer_load_dwordx4 v247, s[4:7], s61 offen offset:1024  lds
  v_mfma_f32_16x16x32_bf16 v[144:147], a[164:167], v[72:75], v[144:147]
  ds_read_b128 a[148:151], v246 offset:8192
  v_mfma_f32_16x16x32_bf16 v[148:151], a[164:167], v[76:79], v[148:151]
  v_mfma_f32_16x16x32_bf16 v[144:147], a[168:171], v[80:83], v[144:147]
  ds_read_b128 a[152:155], v245 offset:18432
  v_mfma_f32_16x16x32_bf16 v[148:151], a[168:171], v[84:87], v[148:151]
  buffer_load_dwordx4 v247, s[4:7], s62 offen offset:2048  lds
  v_mfma_f32_16x16x32_bf16 v[144:147], a[172:175], v[88:91], v[144:147]
  ds_read_b128 a[156:159], v246 offset:18432
  v_mfma_f32_16x16x32_bf16 v[148:151], a[172:175], v[92:95], v[148:151]
  s_waitcnt lgkmcnt(4)
  v_mfma_f32_16x16x32_bf16 v[144:147], a[128:131], v[96:99], v[144:147]
  ds_read_b128 a[160:163], v245 offset:19456
  v_mfma_f32_16x16x32_bf16 v[148:151], a[128:131], v[100:103], v[148:151]
  buffer_load_dwordx4 v247, s[4:7], s63 offen offset:3072  lds
  v_mfma_f32_16x16x32_bf16 v[144:147], a[132:135], v[104:107], v[144:147]
  ds_read_b128 a[164:167], v246 offset:19456
  v_mfma_f32_16x16x32_bf16 v[148:151], a[132:135], v[108:111], v[148:151]
  v_mfma_f32_16x16x32_bf16 v[144:147], a[136:139], v[112:115], v[144:147]
  ds_read_b128 a[168:171], v245 offset:20480
  s_add_u32 m0, s71, 40960
  v_mfma_f32_16x16x32_bf16 v[148:151], a[136:139], v[116:119], v[148:151]
  buffer_load_dwordx4 v247, s[4:7], s64 offen offset:0  lds
  v_mfma_f32_16x16x32_bf16 v[144:147], a[140:143], v[120:123], v[144:147]
  ds_read_b128 a[172:175], v246 offset:20480
  v_mfma_f32_16x16x32_bf16 v[148:151], a[140:143], v[124:127], v[148:151]
  s_waitcnt lgkmcnt(4)
  v_mfma_f32_16x16x32_bf16 v[144:147], a[144:147], v[128:131], v[144:147]
  ds_read_b128 a[128:131], v245 offset:21504
  v_mfma_f32_16x16x32_bf16 v[148:151], a[144:147], v[132:135], v[148:151]
  buffer_load_dwordx4 v247, s[4:7], s65 offen offset:1024  lds
  v_mfma_f32_16x16x32_bf16 v[144:147], a[148:151], v[136:139], v[144:147]
  ds_read_b128 a[132:135], v246 offset:21504
  v_mfma_f32_16x16x32_bf16 v[148:151], a[148:151], v[140:143], v[148:151]
  v_mfma_f32_16x16x32_bf16 v[152:155], a[152:155], v[0:3], 0
  ds_read_b128 a[136:139], v245 offset:22528
  v_mfma_f32_16x16x32_bf16 v[156:159], a[152:155], v[4:7], 0
  buffer_load_dwordx4 v247, s[4:7], s66 offen offset:2048  lds
  v_mfma_f32_16x16x32_bf16 v[152:155], a[156:159], v[8:11], v[152:155]
  ds_read_b128 a[140:143], v246 offset:22528
  v_mfma_f32_16x16x32_bf16 v[156:159], a[156:159], v[12:15], v[156:159]
  s_waitcnt lgkmcnt(4)
  v_mfma_f32_16x16x32_bf16 v[152:155], a[160:163], v[16:19], v[152:155]
  ds_read_b128 a[144:147], v245 offset:23552
  v_mfma_f32_16x16x32_bf16 v[156:159], a[160:163], v[20:23], v[156:159]
  buffer_load_dwordx4 v247, s[4:7], s67 offen offset:3072  lds
  v_mfma_f32_16x16x32_bf16 v[152:155], a[164:167], v[24:27], v[152:155]
  ds_read_b128 a[148:151], v246 offset:23552
  v_mfma_f32_16x16x32_bf16 v[156:159], a[164:167], v[28:31], v[156:159]
  v_mfma_f32_16x16x32_bf16 v[152:155], a[168:171], v[32:35], v[152:155]
  ds_read_b128 a[152:155], v245 offset:24576
  s_add_u32 m0, s71, 45056
  v_mfma_f32_16x16x32_bf16 v[156:159], a[168:171], v[36:39], v[156:159]
  buffer_load_dwordx4 v247, s[4:7], s68 offen offset:0  lds
  v_mfma_f32_16x16x32_bf16 v[152:155], a[172:175], v[40:43], v[152:155]
  ds_read_b128 a[156:159], v246 offset:24576
  v_mfma_f32_16x16x32_bf16 v[156:159], a[172:175], v[44:47], v[156:159]
  buffer_store_dwordx2 v[164:165], v250, s[16:19], s76 offen nt
  s_waitcnt lgkmcnt(4)
  v_mfma_f32_16x16x32_bf16 v[152:155], a[128:131], v[48:51], v[152:155]
  ds_read_b128 a[160:163], v245 offset:25600
  v_mfma_f32_16x16x32_bf16 v[156:159], a[128:131], v[52:55], v[156:159]
  buffer_store_dwordx2 v[166:167], v248, s[16:19], s76 offen nt
  v_cvt_pk_bf16_f32 v160, v144, v148
  v_cvt_pk_bf16_f32 v161, v145, v149
  v_cvt_pk_bf16_f32 v162, v146, v150
  v_mfma_f32_16x16x32_bf16 v[152:155], a[132:135], v[56:59], v[152:155]
  ds_read_b128 a[164:167], v246 offset:25600
  v_cvt_pk_bf16_f32 v163, v147, v151
  v_cndmask_b32_dpp v169, v160, v161, vcc row_ror:8 row_mask:0xf bank_mask:0xf
  v_cndmask_b32_dpp v171, v162, v163, vcc row_ror:8 row_mask:0xf bank_mask:0xf
  s_not_b64 vcc, vcc
  v_cndmask_b32_dpp v168, v161, v160, vcc row_ror:8 row_mask:0xf bank_mask:0xf
  v_mfma_f32_16x16x32_bf16 v[156:159], a[132:135], v[60:63], v[156:159]
  v_cndmask_b32_dpp v170, v163, v162, vcc row_ror:8 row_mask:0xf bank_mask:0xf
  buffer_store_dwordx2 v[168:169], v250, s[16:19], s88 offen nt
  v_mfma_f32_16x16x32_bf16 v[152:155], a[136:139], v[64:67], v[152:155]
  ds_read_b128 a[168:171], v245 offset:26624
  v_mfma_f32_16x16x32_bf16 v[156:159], a[136:139], v[68:71], v[156:159]
  buffer_store_dwordx2 v[170:171], v248, s[16:19], s88 offen nt
  v_mfma_f32_16x16x32_bf16 v[152:155], a[140:143], v[72:75], v[152:155]
  ds_read_b128 a[172:175], v246 offset:26624
  v_cvt_pk_bf16_f32 v160, v192, v196
  v_mfma_f32_16x16x32_bf16 v[156:159], a[140:143], v[76:79], v[156:159]
  v_cvt_pk_bf16_f32 v161, v193, v197
  s_waitcnt lgkmcnt(4)
  v_mfma_f32_16x16x32_bf16 v[152:155], a[144:147], v[80:83], v[152:155]
  s_waitcnt vmcnt(13)
  s_barrier
  v_add_u32 v245, 4294868992, v245
  ds_read_b128 a[128:131], v245 offset:0
  v_mfma_f32_16x16x32_bf16 v[156:159], a[144:147], v[84:87], v[156:159]
  v_cvt_pk_bf16_f32 v162, v194, v198
  v_cvt_pk_bf16_f32 v163, v195, v199
  v_mfma_f32_16x16x32_bf16 v[152:155], a[148:151], v[88:91], v[152:155]
  v_add_u32 v246, 4294868992, v246
  ds_read_b128 a[132:135], v246 offset:0
  v_mfma_f32_16x16x32_bf16 v[156:159], a[148:151], v[92:95], v[156:159]
  v_cndmask_b32_dpp v164, v161, v160, vcc row_ror:8 row_mask:0xf bank_mask:0xf
  v_cndmask_b32_dpp v166, v163, v162, vcc row_ror:8 row_mask:0xf bank_mask:0xf
  v_mfma_f32_16x16x32_bf16 v[152:155], a[152:155], v[96:99], v[152:155]
  ds_read_b128 a[136:139], v245 offset:1024
  s_not_b64 vcc, vcc
  v_mfma_f32_16x16x32_bf16 v[156:159], a[152:155], v[100:103], v[156:159]
  v_cndmask_b32_dpp v165, v160, v161, vcc row_ror:8 row_mask:0xf bank_mask:0xf
  v_cndmask_b32_dpp v167, v162, v163, vcc row_ror:8 row_mask:0xf bank_mask:0xf
  v_mfma_f32_16x16x32_bf16 v[152:155], a[156:159], v[104:107], v[152:155]
  ds_read_b128 a[140:143], v246 offset:1024
  buffer_store_dwordx2 v[164:165], v250, s[16:19], s77 offen nt
  v_mfma_f32_16x16x32_bf16 v[156:159], a[156:159], v[108:111], v[156:159]
  s_waitcnt lgkmcnt(4)
  v_mfma_f32_16x16x32_bf16 v[152:155], a[160:163], v[112:115], v[152:155]
  ds_read_b128 a[144:147], v245 offset:2048
  buffer_store_dwordx2 v[166:167], v248, s[16:19], s77 offen nt
  v_mfma_f32_16x16x32_bf16 v[156:159], a[160:163], v[116:119], v[156:159]
  v_cvt_pk_bf16_f32 v160, v200, v204
  v_cvt_pk_bf16_f32 v161, v201, v205
  v_mfma_f32_16x16x32_bf16 v[152:155], a[164:167], v[120:123], v[152:155]
  ds_read_b128 a[148:151], v246 offset:2048
  v_cvt_pk_bf16_f32 v162, v202, v206
  v_mfma_f32_16x16x32_bf16 v[156:159], a[164:167], v[124:127], v[156:159]
  v_cvt_pk_bf16_f32 v163, v203, v207
  v_cndmask_b32_dpp v169, v160, v161, vcc row_ror:8 row_mask:0xf bank_mask:0xf
  v_mfma_f32_16x16x32_bf16 v[152:155], a[168:171], v[128:131], v[152:155]
  ds_read_b128 a[152:155], v245 offset:3072
  v_cndmask_b32_dpp v171, v162, v163, vcc row_ror:8 row_mask:0xf bank_mask:0xf
  v_mfma_f32_16x16x32_bf16 v[156:159], a[168:171], v[132:135], v[156:159]
  s_not_b64 vcc, vcc
  v_cndmask_b32_dpp v168, v161, v160, vcc row_ror:8 row_mask:0xf bank_mask:0xf
  v_mfma_f32_16x16x32_bf16 v[152:155], a[172:175], v[136:139], v[152:155]
  ds_read_b128 a[156:159], v246 offset:3072
  v_cndmask_b32_dpp v170, v163, v162, vcc row_ror:8 row_mask:0xf bank_mask:0xf
  v_mfma_f32_16x16x32_bf16 v[156:159], a[172:175], v[140:143], v[156:159]
  buffer_store_dwordx2 v[168:169], v250, s[16:19], s78 offen nt
  s_waitcnt lgkmcnt(4)
  v_mfma_f32_16x16x32_bf16 v[144:147], a[128:131], v[0:3], 0
  ds_read_b128 a[160:163], v245 offset:4096
  v_mfma_f32_16x16x32_bf16 v[148:151], a[128:131], v[4:7], 0
  buffer_store_dwordx2 v[170:171], v248, s[16:19], s78 offen nt
  v_mfma_f32_16x16x32_bf16 v[144:147], a[132:135], v[8:11], v[144:147]
  ds_read_b128 a[164:167], v246 offset:4096
  v_cvt_pk_bf16_f32 v160, v208, v212
  v_mfma_f32_16x16x32_bf16 v[148:151], a[132:135], v[12:15], v[148:151]
  v_cvt_pk_bf16_f32 v161, v209, v213
  v_cvt_pk_bf16_f32 v162, v210, v214
  v_mfma_f32_16x16x32_bf16 v[144:147], a[136:139], v[16:19], v[144:147]
  ds_read_b128 a[168:171], v245 offset:5120
  v_cvt_pk_bf16_f32 v163, v211, v215
  v_mfma_f32_16x16x32_bf16 v[148:151], a[136:139], v[20:23], v[148:151]
  v_cndmask_b32_dpp v164, v161, v160, vcc row_ror:8 row_mask:0xf bank_mask:0xf
  v_cndmask_b32_dpp v166, v163, v162, vcc row_ror:8 row_mask:0xf bank_mask:0xf
  v_mfma_f32_16x16x32_bf16 v[144:147], a[140:143], v[24:27], v[144:147]
  ds_read_b128 a[172:175], v246 offset:5120
  s_not_b64 vcc, vcc
  v_mfma_f32_16x16x32_bf16 v[148:151], a[140:143], v[28:31], v[148:151]
  v_cndmask_b32_dpp v165, v160, v161, vcc row_ror:8 row_mask:0xf bank_mask:0xf
  s_waitcnt lgkmcnt(4)
  v_mfma_f32_16x16x32_bf16 v[144:147], a[144:147], v[32:35], v[144:147]
  ds_read_b128 a[128:131], v245 offset:6144
  v_cndmask_b32_dpp v167, v162, v163, vcc row_ror:8 row_mask:0xf bank_mask:0xf
  v_mfma_f32_16x16x32_bf16 v[148:151], a[144:147], v[36:39], v[148:151]
  buffer_store_dwordx2 v[164:165], v250, s[16:19], s79 offen nt
  v_mfma_f32_16x16x32_bf16 v[144:147], a[148:151], v[40:43], v[144:147]
  ds_read_b128 a[132:135], v246 offset:6144
  v_mfma_f32_16x16x32_bf16 v[148:151], a[148:151], v[44:47], v[148:151]
  buffer_store_dwordx2 v[166:167], v248, s[16:19], s79 offen nt
  v_mfma_f32_16x16x32_bf16 v[144:147], a[152:155], v[48:51], v[144:147]
  ds_read_b128 a[136:139], v245 offset:7168
  v_cvt_pk_bf16_f32 v160, v152, v156
  v_mfma_f32_16x16x32_bf16 v[148:151], a[152:155], v[52:55], v[148:151]
  v_cvt_pk_bf16_f32 v161, v153, v157
  v_cvt_pk_bf16_f32 v162, v154, v158
  v_mfma_f32_16x16x32_bf16 v[144:147], a[156:159], v[56:59], v[144:147]
  ds_read_b128 a[140:143], v246 offset:7168
  v_cvt_pk_bf16_f32 v163, v155, v159
  v_mfma_f32_16x16x32_bf16 v[148:151], a[156:159], v[60:63], v[148:151]
  v_cndmask_b32_dpp v169, v160, v161, vcc row_ror:8 row_mask:0xf bank_mask:0xf
  s_waitcnt lgkmcnt(4)
  v_mfma_f32_16x16x32_bf16 v[144:147], a[160:163], v[64:67], v[144:147]
  ds_read_b128 a[144:147], v245 offset:8192
  v_cndmask_b32_dpp v171, v162, v163, vcc row_ror:8 row_mask:0xf bank_mask:0xf
  v_mfma_f32_16x16x32_bf16 v[148:151], a[160:163], v[68:71], v[148:151]
  s_not_b64 vcc, vcc
  v_cndmask_b32_dpp v168, v161, v160, vcc row_ror:8 row_mask:0xf bank_mask:0xf
  v_mfma_f32_16x16x32_bf16 v[144:147], a[164:167], v[72:75], v[144:147]
  ds_read_b128 a[148:151], v246 offset:8192
  v_cndmask_b32_dpp v170, v163, v162, vcc row_ror:8 row_mask:0xf bank_mask:0xf
  v_mfma_f32_16x16x32_bf16 v[148:151], a[164:167], v[76:79], v[148:151]
  buffer_store_dwordx2 v[168:169], v250, s[16:19], s89 offen nt
  v_mfma_f32_16x16x32_bf16 v[144:147], a[168:171], v[80:83], v[144:147]
  ds_read_b128 a[152:155], v245 offset:18432
  v_mfma_f32_16x16x32_bf16 v[148:151], a[168:171], v[84:87], v[148:151]
  buffer_store_dwordx2 v[170:171], v248, s[16:19], s89 offen nt
  v_mfma_f32_16x16x32_bf16 v[144:147], a[172:175], v[88:91], v[144:147]
  ds_read_b128 a[156:159], v246 offset:18432
  v_cvt_pk_bf16_f32 v160, v216, v220
  v_mfma_f32_16x16x32_bf16 v[148:151], a[172:175], v[92:95], v[148:151]
  v_cvt_pk_bf16_f32 v161, v217, v221
  s_waitcnt lgkmcnt(4)
  v_mfma_f32_16x16x32_bf16 v[144:147], a[128:131], v[96:99], v[144:147]
  ds_read_b128 a[160:163], v245 offset:19456
  v_cvt_pk_bf16_f32 v162, v218, v222
  v_mfma_f32_16x16x32_bf16 v[148:151], a[128:131], v[100:103], v[148:151]
  v_cvt_pk_bf16_f32 v163, v219, v223
  v_cndmask_b32_dpp v164, v161, v160, vcc row_ror:8 row_mask:0xf bank_mask:0xf
  v_mfma_f32_16x16x32_bf16 v[144:147], a[132:135], v[104:107], v[144:147]
  ds_read_b128 a[164:167], v246 offset:19456
  v_cndmask_b32_dpp v166, v163, v162, vcc row_ror:8 row_mask:0xf bank_mask:0xf
  v_mfma_f32_16x16x32_bf16 v[148:151], a[132:135], v[108:111], v[148:151]
  s_not_b64 vcc, vcc
  v_cndmask_b32_dpp v165, v160, v161, vcc row_ror:8 row_mask:0xf bank_mask:0xf
  v_mfma_f32_16x16x32_bf16 v[144:147], a[136:139], v[112:115], v[144:147]
  ds_read_b128 a[168:171], v245 offset:20480
  v_cndmask_b32_dpp v167, v162, v163, vcc row_ror:8 row_mask:0xf bank_mask:0xf
  v_mfma_f32_16x16x32_bf16 v[148:151], a[136:139], v[116:119], v[148:151]
  buffer_store_dwordx2 v[164:165], v250, s[16:19], s80 offen nt
  v_mfma_f32_16x16x32_bf16 v[144:147], a[140:143], v[120:123], v[144:147]
  ds_read_b128 a[172:175], v246 offset:20480
  v_mfma_f32_16x16x32_bf16 v[148:151], a[140:143], v[124:127], v[148:151]
  buffer_store_dwordx2 v[166:167], v248, s[16:19], s80 offen nt
  s_waitcnt lgkmcnt(4)
  v_mfma_f32_16x16x32_bf16 v[144:147], a[144:147], v[128:131], v[144:147]
  ds_read_b128 a[128:131], v245 offset:21504
  v_accvgpr_read_b32 v172, a40
  v_mfma_f32_16x16x32_bf16 v[148:151], a[144:147], v[132:135], v[148:151]
  v_accvgpr_read_b32 v176, a44
  v_cvt_pk_bf16_f32 v160, v172, v176
  v_mfma_f32_16x16x32_bf16 v[144:147], a[148:151], v[136:139], v[144:147]
  ds_read_b128 a[132:135], v246 offset:21504
  v_accvgpr_read_b32 v173, a41
  v_mfma_f32_16x16x32_bf16 v[148:151], a[148:151], v[140:143], v[148:151]
  v_accvgpr_read_b32 v177, a45
  v_cvt_pk_bf16_f32 v161, v173, v177
  v_mfma_f32_16x16x32_bf16 v[152:155], a[152:155], v[0:3], 0
  ds_read_b128 a[136:139], v245 offset:22528
  v_accvgpr_read_b32 v174, a42
  v_mfma_f32_16x16x32_bf16 v[156:159], a[152:155], v[4:7], 0
  v_accvgpr_read_b32 v178, a46
  v_cvt_pk_bf16_f32 v162, v174, v178
  v_mfma_f32_16x16x32_bf16 v[152:155], a[156:159], v[8:11], v[152:155]
  ds_read_b128 a[140:143], v246 offset:22528
  v_accvgpr_read_b32 v175, a43
  v_mfma_f32_16x16x32_bf16 v[156:159], a[156:159], v[12:15], v[156:159]
  v_accvgpr_read_b32 v179, a47
  s_waitcnt lgkmcnt(4)
  v_mfma_f32_16x16x32_bf16 v[152:155], a[160:163], v[16:19], v[152:155]
  ds_read_b128 a[144:147], v245 offset:23552
  v_cvt_pk_bf16_f32 v163, v175, v179
  v_mfma_f32_16x16x32_bf16 v[156:159], a[160:163], v[20:23], v[156:159]
  v_cndmask_b32_dpp v169, v160, v161, vcc row_ror:8 row_mask:0xf bank_mask:0xf
  v_cndmask_b32_dpp v171, v162, v163, vcc row_ror:8 row_mask:0xf bank_mask:0xf
  v_mfma_f32_16x16x32_bf16 v[152:155], a[164:167], v[24:27], v[152:155]
  ds_read_b128 a[148:151], v246 offset:23552
  s_not_b64 vcc, vcc
  v_mfma_f32_16x16x32_bf16 v[156:159], a[164:167], v[28:31], v[156:159]
  v_cndmask_b32_dpp v168, v161, v160, vcc row_ror:8 row_mask:0xf bank_mask:0xf
  v_cndmask_b32_dpp v170, v163, v162, vcc row_ror:8 row_mask:0xf bank_mask:0xf
  buffer_store_dwordx2 v[168:169], v250, s[16:19], s81 offen nt
  v_mfma_f32_16x16x32_bf16 v[152:155], a[168:171], v[32:35], v[152:155]
  ds_read_b128 a[152:155], v245 offset:24576
  v_mfma_f32_16x16x32_bf16 v[156:159], a[168:171], v[36:39], v[156:159]
  buffer_store_dwordx2 v[170:171], v248, s[16:19], s81 offen nt
  v_mfma_f32_16x16x32_bf16 v[152:155], a[172:175], v[40:43], v[152:155]
  ds_read_b128 a[156:159], v246 offset:24576
  v_cvt_pk_bf16_f32 v160, v144, v148
  v_mfma_f32_16x16x32_bf16 v[156:159], a[172:175], v[44:47], v[156:159]
  v_cvt_pk_bf16_f32 v161, v145, v149
  s_waitcnt lgkmcnt(4)
  v_mfma_f32_16x16x32_bf16 v[152:155], a[128:131], v[48:51], v[152:155]
  ds_read_b128 a[160:163], v245 offset:25600
  v_cvt_pk_bf16_f32 v162, v146, v150
  v_mfma_f32_16x16x32_bf16 v[156:159], a[128:131], v[52:55], v[156:159]
  v_cvt_pk_bf16_f32 v163, v147, v151
  v_cndmask_b32_dpp v164, v161, v160, vcc row_ror:8 row_mask:0xf bank_mask:0xf
  v_mfma_f32_16x16x32_bf16 v[152:155], a[132:135], v[56:59], v[152:155]
  ds_read_b128 a[164:167], v246 offset:25600
  v_cndmask_b32_dpp v166, v163, v162, vcc row_ror:8 row_mask:0xf bank_mask:0xf
  v_mfma_f32_16x16x32_bf16 v[156:159], a[132:135], v[60:63], v[156:159]
  s_not_b64 vcc, vcc
  v_cndmask_b32_dpp v165, v160, v161, vcc row_ror:8 row_mask:0xf bank_mask:0xf
  v_mfma_f32_16x16x32_bf16 v[152:155], a[136:139], v[64:67], v[152:155]
  ds_read_b128 a[168:171], v245 offset:26624
  v_cndmask_b32_dpp v167, v162, v163, vcc row_ror:8 row_mask:0xf bank_mask:0xf
  v_mfma_f32_16x16x32_bf16 v[156:159], a[136:139], v[68:71], v[156:159]
  buffer_store_dwordx2 v[164:165], v250, s[16:19], s90 offen nt
  v_mfma_f32_16x16x32_bf16 v[152:155], a[140:143], v[72:75], v[152:155]
  ds_read_b128 a[172:175], v246 offset:26624
  v_mfma_f32_16x16x32_bf16 v[156:159], a[140:143], v[76:79], v[156:159]
  buffer_store_dwordx2 v[166:167], v248, s[16:19], s90 offen nt
  s_waitcnt lgkmcnt(4)
  v_mfma_f32_16x16x32_bf16 v[152:155], a[144:147], v[80:83], v[152:155]
  s_waitcnt vmcnt(18)
  s_barrier
  ds_read_b128 a[128:131], v245 offset:36864
  v_mfma_f32_16x16x32_bf16 v[156:159], a[144:147], v[84:87], v[156:159]
  v_accvgpr_read_b32 v172, a48
  v_accvgpr_read_b32 v176, a52
  v_mfma_f32_16x16x32_bf16 v[152:155], a[148:151], v[88:91], v[152:155]
  ds_read_b128 a[132:135], v246 offset:36864
  v_cvt_pk_bf16_f32 v160, v172, v176
  v_mfma_f32_16x16x32_bf16 v[156:159], a[148:151], v[92:95], v[156:159]
  v_accvgpr_read_b32 v173, a49
  v_accvgpr_read_b32 v177, a53
  v_mfma_f32_16x16x32_bf16 v[152:155], a[152:155], v[96:99], v[152:155]
  ds_read_b128 a[136:139], v245 offset:37888
  v_cvt_pk_bf16_f32 v161, v173, v177
  v_mfma_f32_16x16x32_bf16 v[156:159], a[152:155], v[100:103], v[156:159]
  v_accvgpr_read_b32 v174, a50
  v_accvgpr_read_b32 v178, a54
  v_mfma_f32_16x16x32_bf16 v[152:155], a[156:159], v[104:107], v[152:155]
  ds_read_b128 a[140:143], v246 offset:37888
  v_cvt_pk_bf16_f32 v162, v174, v178
  v_mfma_f32_16x16x32_bf16 v[156:159], a[156:159], v[108:111], v[156:159]
  v_accvgpr_read_b32 v175, a51
  s_waitcnt lgkmcnt(4)
  v_mfma_f32_16x16x32_bf16 v[152:155], a[160:163], v[112:115], v[152:155]
  ds_read_b128 a[144:147], v245 offset:38912
  v_accvgpr_read_b32 v179, a55
  v_mfma_f32_16x16x32_bf16 v[156:159], a[160:163], v[116:119], v[156:159]
  v_cvt_pk_bf16_f32 v163, v175, v179
  v_cndmask_b32_dpp v169, v160, v161, vcc row_ror:8 row_mask:0xf bank_mask:0xf
  v_mfma_f32_16x16x32_bf16 v[152:155], a[164:167], v[120:123], v[152:155]
  ds_read_b128 a[148:151], v246 offset:38912
  v_cndmask_b32_dpp v171, v162, v163, vcc row_ror:8 row_mask:0xf bank_mask:0xf
  v_mfma_f32_16x16x32_bf16 v[156:159], a[164:167], v[124:127], v[156:159]
  s_not_b64 vcc, vcc
  v_cndmask_b32_dpp v168, v161, v160, vcc row_ror:8 row_mask:0xf bank_mask:0xf
  v_cndmask_b32_dpp v170, v163, v162, vcc row_ror:8 row_mask:0xf bank_mask:0xf
  v_mfma_f32_16x16x32_bf16 v[152:155], a[168:171], v[128:131], v[152:155]
  ds_read_b128 a[152:155], v245 offset:39936
  buffer_store_dwordx2 v[168:169], v250, s[16:19], s82 offen nt
  v_mfma_f32_16x16x32_bf16 v[156:159], a[168:171], v[132:135], v[156:159]
  v_mfma_f32_16x16x32_bf16 v[152:155], a[172:175], v[136:139], v[152:155]
  ds_read_b128 a[156:159], v246 offset:39936
  buffer_store_dwordx2 v[170:171], v248, s[16:19], s82 offen nt
  v_mfma_f32_16x16x32_bf16 v[156:159], a[172:175], v[140:143], v[156:159]
  v_accvgpr_read_b32 v172, a56
  s_waitcnt lgkmcnt(4)
  v_mfma_f32_16x16x32_bf16 v[144:147], a[128:131], v[0:3], 0
  ds_read_b128 a[160:163], v245 offset:40960
  v_accvgpr_read_b32 v176, a60
  v_mfma_f32_16x16x32_bf16 v[148:151], a[128:131], v[4:7], 0
  v_cvt_pk_bf16_f32 v160, v172, v176
  v_accvgpr_read_b32 v173, a57
  v_mfma_f32_16x16x32_bf16 v[144:147], a[132:135], v[8:11], v[144:147]
  ds_read_b128 a[164:167], v246 offset:40960
  v_accvgpr_read_b32 v177, a61
  v_mfma_f32_16x16x32_bf16 v[148:151], a[132:135], v[12:15], v[148:151]
  v_cvt_pk_bf16_f32 v161, v173, v177
  v_accvgpr_read_b32 v174, a58
  v_mfma_f32_16x16x32_bf16 v[144:147], a[136:139], v[16:19], v[144:147]
  ds_read_b128 a[168:171], v245 offset:41984
  v_accvgpr_read_b32 v178, a62
  v_mfma_f32_16x16x32_bf16 v[148:151], a[136:139], v[20:23], v[148:151]
  v_cvt_pk_bf16_f32 v162, v174, v178
  v_accvgpr_read_b32 v175, a59
  v_mfma_f32_16x16x32_bf16 v[144:147], a[140:143], v[24:27], v[144:147]
  ds_read_b128 a[172:175], v246 offset:41984
  v_accvgpr_read_b32 v179, a63
  v_mfma_f32_16x16x32_bf16 v[148:151], a[140:143], v[28:31], v[148:151]
  v_cvt_pk_bf16_f32 v163, v175, v179
  v_cndmask_b32_dpp v164, v161, v160, vcc row_ror:8 row_mask:0xf bank_mask:0xf
  s_waitcnt lgkmcnt(4)
  v_mfma_f32_16x16x32_bf16 v[144:147], a[144:147], v[32:35], v[144:147]
  ds_read_b128 a[128:131], v245 offset:43008
  v_cndmask_b32_dpp v166, v163, v162, vcc row_ror:8 row_mask:0xf bank_mask:0xf
  v_mfma_f32_16x16x32_bf16 v[148:151], a[144:147], v[36:39], v[148:151]
  s_not_b64 vcc, vcc
  v_cndmask_b32_dpp v165, v160, v161, vcc row_ror:8 row_mask:0xf bank_mask:0xf
  v_cndmask_b32_dpp v167, v162, v163, vcc row_ror:8 row_mask:0xf bank_mask:0xf
  v_mfma_f32_16x16x32_bf16 v[144:147], a[148:151], v[40:43], v[144:147]
  ds_read_b128 a[132:135], v246 offset:43008
  buffer_store_dwordx2 v[164:165], v250, s[16:19], s83 offen nt
  v_mfma_f32_16x16x32_bf16 v[148:151], a[148:151], v[44:47], v[148:151]
  v_mfma_f32_16x16x32_bf16 v[144:147], a[152:155], v[48:51], v[144:147]
  ds_read_b128 a[136:139], v245 offset:44032
  buffer_store_dwordx2 v[166:167], v248, s[16:19], s83 offen nt
  v_mfma_f32_16x16x32_bf16 v[148:151], a[152:155], v[52:55], v[148:151]
  v_cvt_pk_bf16_f32 v160, v152, v156
  v_cvt_pk_bf16_f32 v161, v153, v157
  v_mfma_f32_16x16x32_bf16 v[144:147], a[156:159], v[56:59], v[144:147]
  ds_read_b128 a[140:143], v246 offset:44032
  v_cvt_pk_bf16_f32 v162, v154, v158
  v_mfma_f32_16x16x32_bf16 v[148:151], a[156:159], v[60:63], v[148:151]
  v_cvt_pk_bf16_f32 v163, v155, v159
  s_waitcnt lgkmcnt(4)
  v_mfma_f32_16x16x32_bf16 v[144:147], a[160:163], v[64:67], v[144:147]
  ds_read_b128 a[144:147], v245 offset:45056
  v_cndmask_b32_dpp v169, v160, v161, vcc row_ror:8 row_mask:0xf bank_mask:0xf
  v_mfma_f32_16x16x32_bf16 v[148:151], a[160:163], v[68:71], v[148:151]
  v_cndmask_b32_dpp v171, v162, v163, vcc row_ror:8 row_mask:0xf bank_mask:0xf
  s_not_b64 vcc, vcc
  v_mfma_f32_16x16x32_bf16 v[144:147], a[164:167], v[72:75], v[144:147]
  ds_read_b128 a[148:151], v246 offset:45056
  v_cndmask_b32_dpp v168, v161, v160, vcc row_ror:8 row_mask:0xf bank_mask:0xf
  v_mfma_f32_16x16x32_bf16 v[148:151], a[164:167], v[76:79], v[148:151]
  v_cndmask_b32_dpp v170, v163, v162, vcc row_ror:8 row_mask:0xf bank_mask:0xf
  buffer_store_dwordx2 v[168:169], v250, s[16:19], s91 offen nt
  v_mfma_f32_16x16x32_bf16 v[144:147], a[168:171], v[80:83], v[144:147]
  ds_read_b128 a[152:155], v245 offset:55296
  v_mfma_f32_16x16x32_bf16 v[148:151], a[168:171], v[84:87], v[148:151]
  buffer_store_dwordx2 v[170:171], v248, s[16:19], s91 offen nt
  v_mfma_f32_16x16x32_bf16 v[144:147], a[172:175], v[88:91], v[144:147]
  ds_read_b128 a[156:159], v246 offset:55296
  v_accvgpr_read_b32 v172, a64
  v_mfma_f32_16x16x32_bf16 v[148:151], a[172:175], v[92:95], v[148:151]
  v_accvgpr_read_b32 v176, a68
  s_waitcnt lgkmcnt(4)
  v_mfma_f32_16x16x32_bf16 v[144:147], a[128:131], v[96:99], v[144:147]
  ds_read_b128 a[160:163], v245 offset:56320
  v_cvt_pk_bf16_f32 v160, v172, v176
  v_mfma_f32_16x16x32_bf16 v[148:151], a[128:131], v[100:103], v[148:151]
  v_accvgpr_read_b32 v173, a65
  v_accvgpr_read_b32 v177, a69
  v_mfma_f32_16x16x32_bf16 v[144:147], a[132:135], v[104:107], v[144:147]
  ds_read_b128 a[164:167], v246 offset:56320
  v_cvt_pk_bf16_f32 v161, v173, v177
  v_mfma_f32_16x16x32_bf16 v[148:151], a[132:135], v[108:111], v[148:151]
  v_accvgpr_read_b32 v174, a66
  v_accvgpr_read_b32 v178, a70
  v_mfma_f32_16x16x32_bf16 v[144:147], a[136:139], v[112:115], v[144:147]
  ds_read_b128 a[168:171], v245 offset:57344
  v_cvt_pk_bf16_f32 v162, v174, v178
  v_mfma_f32_16x16x32_bf16 v[148:151], a[136:139], v[116:119], v[148:151]
  v_accvgpr_read_b32 v175, a67
  v_accvgpr_read_b32 v179, a71
  v_cvt_pk_bf16_f32 v163, v175, v179
  v_mfma_f32_16x16x32_bf16 v[144:147], a[140:143], v[120:123], v[144:147]
  ds_read_b128 a[172:175], v246 offset:57344
  v_cndmask_b32_dpp v164, v161, v160, vcc row_ror:8 row_mask:0xf bank_mask:0xf
  v_mfma_f32_16x16x32_bf16 v[148:151], a[140:143], v[124:127], v[148:151]
  v_cndmask_b32_dpp v166, v163, v162, vcc row_ror:8 row_mask:0xf bank_mask:0xf
  s_waitcnt lgkmcnt(4)
  v_mfma_f32_16x16x32_bf16 v[144:147], a[144:147], v[128:131], v[144:147]
  ds_read_b128 a[128:131], v245 offset:58368
  s_not_b64 vcc, vcc
  v_cndmask_b32_dpp v165, v160, v161, vcc row_ror:8 row_mask:0xf bank_mask:0xf
  v_mfma_f32_16x16x32_bf16 v[148:151], a[144:147], v[132:135], v[148:151]
  v_cndmask_b32_dpp v167, v162, v163, vcc row_ror:8 row_mask:0xf bank_mask:0xf
  buffer_store_dwordx2 v[164:165], v250, s[16:19], s84 offen nt
  v_mfma_f32_16x16x32_bf16 v[144:147], a[148:151], v[136:139], v[144:147]
  ds_read_b128 a[132:135], v246 offset:58368
  v_mfma_f32_16x16x32_bf16 v[148:151], a[148:151], v[140:143], v[148:151]
  buffer_store_dwordx2 v[166:167], v248, s[16:19], s84 offen nt
  v_mfma_f32_16x16x32_bf16 v[152:155], a[152:155], v[0:3], 0
  ds_read_b128 a[136:139], v245 offset:59392
  v_accvgpr_read_b32 v172, a72
  v_mfma_f32_16x16x32_bf16 v[156:159], a[152:155], v[4:7], 0
  v_accvgpr_read_b32 v176, a76
  v_cvt_pk_bf16_f32 v160, v172, v176
  v_mfma_f32_16x16x32_bf16 v[152:155], a[156:159], v[8:11], v[152:155]
  ds_read_b128 a[140:143], v246 offset:59392
  v_accvgpr_read_b32 v173, a73
  v_mfma_f32_16x16x32_bf16 v[156:159], a[156:159], v[12:15], v[156:159]
  v_accvgpr_read_b32 v177, a77
  s_waitcnt lgkmcnt(4)
  v_mfma_f32_16x16x32_bf16 v[152:155], a[160:163], v[16:19], v[152:155]
  ds_read_b128 a[144:147], v245 offset:60416
  v_cvt_pk_bf16_f32 v161, v173, v177
  v_accvgpr_read_b32 v174, a74
  v_mfma_f32_16x16x32_bf16 v[156:159], a[160:163], v[20:23], v[156:159]
  v_accvgpr_read_b32 v178, a78
  v_cvt_pk_bf16_f32 v162, v174, v178
  v_mfma_f32_16x16x32_bf16 v[152:155], a[164:167], v[24:27], v[152:155]
  ds_read_b128 a[148:151], v246 offset:60416
  v_accvgpr_read_b32 v175, a75
  v_accvgpr_read_b32 v179, a79
  v_mfma_f32_16x16x32_bf16 v[156:159], a[164:167], v[28:31], v[156:159]
  v_cvt_pk_bf16_f32 v163, v175, v179
  v_cndmask_b32_dpp v169, v160, v161, vcc row_ror:8 row_mask:0xf bank_mask:0xf
  v_cndmask_b32_dpp v171, v162, v163, vcc row_ror:8 row_mask:0xf bank_mask:0xf
  v_mfma_f32_16x16x32_bf16 v[152:155], a[168:171], v[32:35], v[152:155]
  ds_read_b128 a[152:155], v245 offset:61440
  s_not_b64 vcc, vcc
  v_cndmask_b32_dpp v168, v161, v160, vcc row_ror:8 row_mask:0xf bank_mask:0xf
  v_mfma_f32_16x16x32_bf16 v[156:159], a[168:171], v[36:39], v[156:159]
  v_cndmask_b32_dpp v170, v163, v162, vcc row_ror:8 row_mask:0xf bank_mask:0xf
  buffer_store_dwordx2 v[168:169], v250, s[16:19], s85 offen nt
  v_mfma_f32_16x16x32_bf16 v[152:155], a[172:175], v[40:43], v[152:155]
  ds_read_b128 a[156:159], v246 offset:61440
  v_mfma_f32_16x16x32_bf16 v[156:159], a[172:175], v[44:47], v[156:159]
  buffer_store_dwordx2 v[170:171], v248, s[16:19], s85 offen nt
  s_waitcnt lgkmcnt(4)
  v_mfma_f32_16x16x32_bf16 v[152:155], a[128:131], v[48:51], v[152:155]
  ds_read_b128 a[160:163], v245 offset:62464
  v_cvt_pk_bf16_f32 v160, v144, v148
  v_mfma_f32_16x16x32_bf16 v[156:159], a[128:131], v[52:55], v[156:159]
  v_cvt_pk_bf16_f32 v161, v145, v149
  v_cvt_pk_bf16_f32 v162, v146, v150
  v_mfma_f32_16x16x32_bf16 v[152:155], a[132:135], v[56:59], v[152:155]
  ds_read_b128 a[164:167], v246 offset:62464
  v_cvt_pk_bf16_f32 v163, v147, v151
  v_mfma_f32_16x16x32_bf16 v[156:159], a[132:135], v[60:63], v[156:159]
  v_cndmask_b32_dpp v164, v161, v160, vcc row_ror:8 row_mask:0xf bank_mask:0xf
  v_cndmask_b32_dpp v166, v163, v162, vcc row_ror:8 row_mask:0xf bank_mask:0xf
  v_mfma_f32_16x16x32_bf16 v[152:155], a[136:139], v[64:67], v[152:155]
  ds_read_b128 a[168:171], v245 offset:63488
  s_not_b64 vcc, vcc
  v_mfma_f32_16x16x32_bf16 v[156:159], a[136:139], v[68:71], v[156:159]
  v_cndmask_b32_dpp v165, v160, v161, vcc row_ror:8 row_mask:0xf bank_mask:0xf
  v_cndmask_b32_dpp v167, v162, v163, vcc row_ror:8 row_mask:0xf bank_mask:0xf
  v_mfma_f32_16x16x32_bf16 v[152:155], a[140:143], v[72:75], v[152:155]
  ds_read_b128 a[172:175], v246 offset:63488
  buffer_store_dwordx2 v[164:165], v250, s[16:19], s92 offen nt
  v_mfma_f32_16x16x32_bf16 v[156:159], a[140:143], v[76:79], v[156:159]
  s_waitcnt lgkmcnt(4)
  v_mfma_f32_16x16x32_bf16 v[152:155], a[144:147], v[80:83], v[152:155]
  s_barrier
  v_add_u32 v245, 135168, v245
  ds_read_b128 a[128:131], v245 offset:0
  v_mfma_f32_16x16x32_bf16 v[156:159], a[144:147], v[84:87], v[156:159]
  buffer_store_dwordx2 v[166:167], v248, s[16:19], s92 offen nt
  v_mfma_f32_16x16x32_bf16 v[152:155], a[148:151], v[88:91], v[152:155]
  v_add_u32 v246, 135168, v246
  ds_read_b128 a[132:135], v246 offset:0
  v_mfma_f32_16x16x32_bf16 v[156:159], a[148:151], v[92:95], v[156:159]
  v_accvgpr_read_b32 v172, a80
  v_accvgpr_read_b32 v176, a84
  v_mfma_f32_16x16x32_bf16 v[152:155], a[152:155], v[96:99], v[152:155]
  ds_read_b128 a[136:139], v245 offset:1024
  v_cvt_pk_bf16_f32 v160, v172, v176
  v_mfma_f32_16x16x32_bf16 v[156:159], a[152:155], v[100:103], v[156:159]
  v_accvgpr_read_b32 v173, a81
  v_accvgpr_read_b32 v177, a85
  v_mfma_f32_16x16x32_bf16 v[152:155], a[156:159], v[104:107], v[152:155]
  ds_read_b128 a[140:143], v246 offset:1024
  v_cvt_pk_bf16_f32 v161, v173, v177
  v_mfma_f32_16x16x32_bf16 v[156:159], a[156:159], v[108:111], v[156:159]
  v_accvgpr_read_b32 v174, a82
  s_waitcnt lgkmcnt(4)
  v_mfma_f32_16x16x32_bf16 v[152:155], a[160:163], v[112:115], v[152:155]
  ds_read_b128 a[144:147], v245 offset:2048
  v_accvgpr_read_b32 v178, a86
  v_mfma_f32_16x16x32_bf16 v[156:159], a[160:163], v[116:119], v[156:159]
  v_cvt_pk_bf16_f32 v162, v174, v178
  v_accvgpr_read_b32 v175, a83
  v_mfma_f32_16x16x32_bf16 v[152:155], a[164:167], v[120:123], v[152:155]
  ds_read_b128 a[148:151], v246 offset:2048
  v_accvgpr_read_b32 v179, a87
  v_cvt_pk_bf16_f32 v163, v175, v179
  v_mfma_f32_16x16x32_bf16 v[156:159], a[164:167], v[124:127], v[156:159]
  v_cndmask_b32_dpp v169, v160, v161, vcc row_ror:8 row_mask:0xf bank_mask:0xf
  v_cndmask_b32_dpp v171, v162, v163, vcc row_ror:8 row_mask:0xf bank_mask:0xf
  v_mfma_f32_16x16x32_bf16 v[152:155], a[168:171], v[128:131], v[152:155]
  ds_read_b128 a[152:155], v245 offset:3072
  s_not_b64 vcc, vcc
  v_cndmask_b32_dpp v168, v161, v160, vcc row_ror:8 row_mask:0xf bank_mask:0xf
  v_mfma_f32_16x16x32_bf16 v[156:159], a[168:171], v[132:135], v[156:159]
  v_cndmask_b32_dpp v170, v163, v162, vcc row_ror:8 row_mask:0xf bank_mask:0xf
  buffer_store_dwordx2 v[168:169], v250, s[16:19], s86 offen nt
  v_mfma_f32_16x16x32_bf16 v[152:155], a[172:175], v[136:139], v[152:155]
  ds_read_b128 a[156:159], v246 offset:3072
  v_mfma_f32_16x16x32_bf16 v[156:159], a[172:175], v[140:143], v[156:159]
  buffer_store_dwordx2 v[170:171], v248, s[16:19], s86 offen nt
  s_waitcnt lgkmcnt(4)
  s_bitcmp1_b32 s3, 0
  s_cbranch_scc1 Lmore
  s_nop 3
  v_cvt_pk_bf16_f32 v160, v152, v156
  v_cvt_pk_bf16_f32 v161, v153, v157
  v_cvt_pk_bf16_f32 v162, v154, v158
  v_cvt_pk_bf16_f32 v163, v155, v159
  v_cndmask_b32_dpp v164, v161, v160, vcc row_ror:8 row_mask:0xf bank_mask:0xf
  s_nop 0
  v_cndmask_b32_dpp v166, v163, v162, vcc row_ror:8 row_mask:0xf bank_mask:0xf
  s_not_b64 vcc, vcc
  v_cndmask_b32_dpp v165, v160, v161, vcc row_ror:8 row_mask:0xf bank_mask:0xf
  v_cndmask_b32_dpp v167, v162, v163, vcc row_ror:8 row_mask:0xf bank_mask:0xf
  buffer_store_dwordx2 v[164:165], v250, s[16:19], s93 offen nt
  buffer_store_dwordx2 v[166:167], v248, s[16:19], s93 offen nt
  v_accvgpr_read_b32 v172, a88
  v_accvgpr_read_b32 v176, a92
  v_cvt_pk_bf16_f32 v160, v172, v176
  v_accvgpr_read_b32 v173, a89
  v_accvgpr_read_b32 v177, a93
  v_cvt_pk_bf16_f32 v161, v173, v177
  v_accvgpr_read_b32 v174, a90
  v_accvgpr_read_b32 v178, a94
  v_cvt_pk_bf16_f32 v162, v174, v178
  v_accvgpr_read_b32 v175, a91
  v_accvgpr_read_b32 v179, a95
  v_cvt_pk_bf16_f32 v163, v175, v179
  v_cndmask_b32_dpp v169, v160, v161, vcc row_ror:8 row_mask:0xf bank_mask:0xf
  v_cndmask_b32_dpp v171, v162, v163, vcc row_ror:8 row_mask:0xf bank_mask:0xf
  s_not_b64 vcc, vcc
  v_cndmask_b32_dpp v168, v161, v160, vcc row_ror:8 row_mask:0xf bank_mask:0xf
  v_cndmask_b32_dpp v170, v163, v162, vcc row_ror:8 row_mask:0xf bank_mask:0xf
  buffer_store_dwordx2 v[168:169], v250, s[16:19], s87 offen nt
  buffer_store_dwordx2 v[170:171], v248, s[16:19], s87 offen nt
  s_endpgm
Lmore:
  v_mfma_f32_16x16x32_bf16 v[144:147], a[128:131], v[0:3], 0
  ds_read_b128 a[160:163], v245 offset:4096
  v_accvgpr_read_b32 v172, a88
  v_mfma_f32_16x16x32_bf16 v[148:151], a[128:131], v[4:7], 0
  v_accvgpr_read_b32 v176, a92
  v_cvt_pk_bf16_f32 v160, v172, v176
  v_mfma_f32_16x16x32_bf16 v[144:147], a[132:135], v[8:11], v[144:147]
  ds_read_b128 a[164:167], v246 offset:4096
  v_accvgpr_read_b32 v173, a89
  v_mfma_f32_16x16x32_bf16 v[148:151], a[132:135], v[12:15], v[148:151]
  v_accvgpr_read_b32 v177, a93
  v_cvt_pk_bf16_f32 v161, v173, v177
  v_accvgpr_read_b32 v174, a90
  v_accvgpr_read_b32 v178, a94
  v_mfma_f32_16x16x32_bf16 v[144:147], a[136:139], v[16:19], v[144:147]
  ds_read_b128 a[168:171], v245 offset:5120
  v_cvt_pk_bf16_f32 v162, v174, v178
  v_accvgpr_read_b32 v175, a91
  v_accvgpr_read_b32 v179, a95
  v_mfma_f32_16x16x32_bf16 v[148:151], a[136:139], v[20:23], v[148:151]
  v_cvt_pk_bf16_f32 v163, v175, v179
  v_cndmask_b32_dpp v164, v161, v160, vcc row_ror:8 row_mask:0xf bank_mask:0xf
  s_nop 0
  v_cndmask_b32_dpp v166, v163, v162, vcc row_ror:8 row_mask:0xf bank_mask:0xf
  s_not_b64 vcc, vcc
  v_cndmask_b32_dpp v165, v160, v161, vcc row_ror:8 row_mask:0xf bank_mask:0xf
  v_mfma_f32_16x16x32_bf16 v[144:147], a[140:143], v[24:27], v[144:147]
  ds_read_b128 a[172:175], v246 offset:5120
  v_cndmask_b32_dpp v167, v162, v163, vcc row_ror:8 row_mask:0xf bank_mask:0xf
  buffer_store_dwordx2 v[164:165], v250, s[16:19], s87 offen nt
  v_mfma_f32_16x16x32_bf16 v[148:151], a[140:143], v[28:31], v[148:151]
  s_waitcnt lgkmcnt(4)
  v_mfma_f32_16x16x32_bf16 v[144:147], a[144:147], v[32:35], v[144:147]
  ds_read_b128 a[128:131], v245 offset:6144
  buffer_store_dwordx2 v[166:167], v248, s[16:19], s87 offen nt
  v_cvt_pk_bf16_f32 v160, v152, v156
  v_cvt_pk_bf16_f32 v161, v153, v157
  v_mfma_f32_16x16x32_bf16 v[148:151], a[144:147], v[36:39], v[148:151]
  v_cvt_pk_bf16_f32 v162, v154, v158
  v_cvt_pk_bf16_f32 v163, v155, v159
  v_cndmask_b32_dpp v169, v160, v161, vcc row_ror:8 row_mask:0xf bank_mask:0xf
  v_cndmask_b32_dpp v171, v162, v163, vcc row_ror:8 row_mask:0xf bank_mask:0xf
  s_not_b64 vcc, vcc
  v_mfma_f32_16x16x32_bf16 v[144:147], a[148:151], v[40:43], v[144:147]
  ds_read_b128 a[132:135], v246 offset:6144
  v_cndmask_b32_dpp v168, v161, v160, vcc row_ror:8 row_mask:0xf bank_mask:0xf
  v_cndmask_b32_dpp v170, v163, v162, vcc row_ror:8 row_mask:0xf bank_mask:0xf
  buffer_store_dwordx2 v[168:169], v250, s[16:19], s93 offen nt
  v_mfma_f32_16x16x32_bf16 v[148:151], a[148:151], v[44:47], v[148:151]
  v_mfma_f32_16x16x32_bf16 v[144:147], a[152:155], v[48:51], v[144:147]
  ds_read_b128 a[136:139], v245 offset:7168
  buffer_store_dwordx2 v[170:171], v248, s[16:19], s93 offen nt
  v_mfma_f32_16x16x32_bf16 v[148:151], a[152:155], v[52:55], v[148:151]
  v_mfma_f32_16x16x32_bf16 v[144:147], a[156:159], v[56:59], v[144:147]
  ds_read_b128 a[140:143], v246 offset:7168
  v_mfma_f32_16x16x32_bf16 v[148:151], a[156:159], v[60:63], v[148:151]
  s_waitcnt lgkmcnt(4)
  v_mfma_f32_16x16x32_bf16 v[144:147], a[160:163], v[64:67], v[144:147]
  ds_read_b128 a[144:147], v245 offset:8192
  v_mfma_f32_16x16x32_bf16 v[148:151], a[160:163], v[68:71], v[148:151]
  v_mfma_f32_16x16x32_bf16 v[144:147], a[164:167], v[72:75], v[144:147]
  ds_read_b128 a[148:151], v246 offset:8192
  v_mfma_f32_16x16x32_bf16 v[148:151], a[164:167], v[76:79], v[148:151]
  v_mfma_f32_16x16x32_bf16 v[144:147], a[168:171], v[80:83], v[144:147]
  v_mfma_f32_16x16x32_bf16 v[148:151], a[168:171], v[84:87], v[148:151]
  v_mfma_f32_16x16x32_bf16 v[144:147], a[172:175], v[88:91], v[144:147]
  v_mfma_f32_16x16x32_bf16 v[148:151], a[172:175], v[92:95], v[148:151]
  s_waitcnt lgkmcnt(2)
  v_mfma_f32_16x16x32_bf16 v[144:147], a[128:131], v[96:99], v[144:147]
  v_mfma_f32_16x16x32_bf16 v[148:151], a[128:131], v[100:103], v[148:151]
  v_mfma_f32_16x16x32_bf16 v[144:147], a[132:135], v[104:107], v[144:147]
  v_mfma_f32_16x16x32_bf16 v[148:151], a[132:135], v[108:111], v[148:151]
  v_mfma_f32_16x16x32_bf16 v[144:147], a[136:139], v[112:115], v[144:147]
  v_mfma_f32_16x16x32_bf16 v[148:151], a[136:139], v[116:119], v[148:151]
  v_mfma_f32_16x16x32_bf16 v[144:147], a[140:143], v[120:123], v[144:147]
  v_mfma_f32_16x16x32_bf16 v[148:151], a[140:143], v[124:127], v[148:151]
  s_waitcnt lgkmcnt(0)
  v_mfma_f32_16x16x32_bf16 v[144:147], a[144:147], v[128:131], v[144:147]
  v_mfma_f32_16x16x32_bf16 v[148:151], a[144:147], v[132:135], v[148:151]
  v_mfma_f32_16x16x32_bf16 v[144:147], a[148:151], v[136:139], v[144:147]
  v_mfma_f32_16x16x32_bf16 v[148:151], a[148:151], v[140:143], v[148:151]
  s_nop 7
  v_cvt_pk_bf16_f32 v160, v144, v148
  v_cvt_pk_bf16_f32 v161, v145, v149
  v_cvt_pk_bf16_f32 v162, v146, v150
  v_cvt_pk_bf16_f32 v163, v147, v151
  v_cndmask_b32_dpp v164, v161, v160, vcc row_ror:8 row_mask:0xf bank_mask:0xf
  s_nop 0
  v_cndmask_b32_dpp v166, v163, v162, vcc row_ror:8 row_mask:0xf bank_mask:0xf
  s_not_b64 vcc, vcc
  v_cndmask_b32_dpp v165, v160, v161, vcc row_ror:8 row_mask:0xf bank_mask:0xf
  v_cndmask_b32_dpp v167, v162, v163, vcc row_ror:8 row_mask:0xf bank_mask:0xf
  buffer_store_dwordx2 v[164:165], v250, s[16:19], s94 offen nt
  buffer_store_dwordx2 v[166:167], v248, s[16:19], s94 offen nt
  s_endpgm
Lend:
  s_endpgm
.section .rodata,"a"
.p2align 6
.amdhsa_kernel standalone__weight_only_int_squeezellm__prompt_kernel
  .amdhsa_next_free_vgpr 512
  .amdhsa_next_free_sgpr 102
  .amdhsa_accum_offset 256
  .amdhsa_group_segment_fixed_size 0
  .amdhsa_kernarg_size 48
  .amdhsa_user_sgpr_count 2
  .amdhsa_user_sgpr_kernarg_segment_ptr 1
  .amdhsa_system_sgpr_workgroup_id_x 1
.end_amdhsa_kernel
```
